```python
import torch

def _softmax(x, axis=-1):
    return torch.softmax(x, dim=axis)
def _gelu(x):
    return torch.nn.functional.gelu(x, approximate="tanh")
def _silu(x):
    return torch.nn.functional.silu(x)
def _sigmoid(x):
    return torch.sigmoid(x)
def _layernorm(x, axis=-1, eps=1e-5):
    m = x.mean(dim=axis, keepdim=True)
    v = x.var(dim=axis, keepdim=True, unbiased=False)
    return (x - m) / torch.sqrt(v + eps)
def _scatter_add(tgt, idx, src, axis=0):
    return tgt.clone().index_add_(axis, idx, src)
def _segment_sum(src, seg, n):
    out = torch.zeros((n,) + src.shape[1:], dtype=src.dtype)
    return out.index_add_(0, seg, src)
def _pad(x, pw):
    flat = tuple(v for pair in reversed(pw) for v in pair)
    return torch.nn.functional.pad(x, flat)

kernel_name = 'gated_mix__softmax_full_mha__linear_attn_block__prompt'

def setup_inputs():

    _w = (lambda a: (lambda t: t.to(torch.bfloat16) if t.is_floating_point() else t)(torch.as_tensor(a)))
    def _A_setup():
        B, S, D = 1, 2048, 512
        return {
            "x": _w((lambda *s: torch.randn(*s, dtype=torch.bfloat16) * 0.05)(B, S, D)),
            "wqkv": _w((lambda *s: torch.randn(*s, dtype=torch.bfloat16) * 0.8)(D, 3 * D)),
            "wo": _w((lambda *s: torch.randn(*s, dtype=torch.bfloat16) * 0.05)(D, D)),
        }
    _A_in = _A_setup()

    def _B_setup():
        B, S, D = 1, 2048, 512
        return {
            "x": _w((lambda *s: torch.randn(*s, dtype=torch.bfloat16) * 0.05)(B, S, D)),
            "wqkv": _w((lambda *s: torch.randn(*s, dtype=torch.bfloat16) * 0.8)(D, 3 * D)),
            "wo": _w((lambda *s: torch.randn(*s, dtype=torch.bfloat16) * 0.2)(D, D)),
        }
    _B_in = _B_setup()

    return {
        "A_x": _A_in["x"],
        "A_wqkv": _A_in["wqkv"],
        "A_wo": _A_in["wo"],
        "B_x": _B_in["x"],
        "B_wqkv": _B_in["wqkv"],
        "B_wo": _B_in["wo"],
        "gate_w": _w((lambda *s: torch.randn(*s, dtype=torch.bfloat16) * 0.05)(512) * 16.0),
    }

def reference(A_x, A_wqkv, A_wo, B_x, B_wqkv, B_wo, gate_w):
    def _A_ref(x, wqkv, wo):
        B, S, D = x.shape
        H = 32; Dh = D // H
        qkv = (lambda x, *d: x.permute(*d))((x @ wqkv).reshape(B, S, 3, H, Dh), 2, 0, 3, 1, 4)
        q, k, v = qkv[0], qkv[1], qkv[2]
        scale = Dh ** -0.5
        scores = torch.einsum("bhqd,bhkd->bhqk", q, k) * scale
        p = _softmax(scores, axis=-1)
        o = torch.einsum("bhqk,bhkd->bhqd", p, v)
        return (lambda x, *d: x.permute(*d))(o, 0, 2, 1, 3).reshape(B, S, D) @ wo

    def _B_ref(x, wqkv, wo):
        B, S, D = x.shape
        H = 32; Dh = D // H
        qkv = (lambda x, *d: x.permute(*d))((x @ wqkv).reshape(B, S, 3, H, Dh), 2, 0, 3, 1, 4)
        q, k, v = qkv[0], qkv[1], qkv[2]
        phi = lambda t: torch.where(t > 0, t + 1, torch.exp(t)) + 1e-6
        pq, pk = phi(q), phi(k)
        kv = torch.einsum("bhsd,bhse->bhde", pk, v)
        z = torch.einsum("bhsd->bhd", pk)
        num = torch.einsum("bhqd,bhde->bhqe", pq, kv)
        den = torch.einsum("bhqd,bhd->bhq", pq, z)[..., None] + 1e-6
        o = num / den
        return (lambda x, *d: x.permute(*d))(o, 0, 2, 1, 3).reshape(B, S, D) @ wo

    x = A_x
    g = _sigmoid((x * gate_w).sum(-1, keepdims=True))
    a = _A_ref(x, A_wqkv, A_wo)
    b = _B_ref(x, B_wqkv, B_wo)
    return g * a + (1 - g) * b
```

```asm
; @launch grid=(256,1,1) block=(512,1,1) lds=163840
.amdgcn_target "amdgcn-amd-amdhsa--gfx950"
.text
.globl gated_mix__softmax_full_mha__linear_attn_block__prompt_kernel
.p2align 8
.type gated_mix__softmax_full_mha__linear_attn_block__prompt_kernel,@function
gated_mix__softmax_full_mha__linear_attn_block__prompt_kernel:
    s_cmp_ge_u32 s2, 256
    s_cbranch_scc1 L_end
    s_load_dwordx2 s[24:25], s[0:1], 0
    s_load_dwordx2 s[28:29], s[0:1], 8
    s_load_dwordx2 s[52:53], s[0:1], 72
    s_load_dwordx2 s[32:33], s[0:1], 32
    s_load_dwordx2 s[36:37], s[0:1], 16
    s_load_dwordx2 s[40:41], s[0:1], 40
    s_load_dwordx2 s[44:45], s[0:1], 48
    s_load_dwordx2 s[48:49], s[0:1], 56
    v_lshrrev_b32 v2, 6, v0
    v_and_b32 v1, 63, v0
    v_readfirstlane_b32 s61, v2
    s_mov_b32 s26, 2097152
    s_mov_b32 s27, 0x20000
    s_mov_b32 s30, 1572864
    s_mov_b32 s31, 0x20000
    s_mov_b32 s34, 1572864
    s_mov_b32 s35, 0x20000
    s_mov_b32 s38, 524288
    s_mov_b32 s39, 0x20000
    s_mov_b32 s42, 524288
    s_mov_b32 s43, 0x20000
    s_mov_b32 s46, 1024
    s_mov_b32 s47, 0x20000
    s_mov_b32 s50, 2097152
    s_mov_b32 s51, 0x20000
    s_mov_b32 s54, 16777216
    s_mov_b32 s55, 0x20000
    s_and_b32 s72, s2, 7
    s_lshr_b32 s73, s2, 3
    s_and_b32 s58, s72, 1
    s_lshl_b32 s58, s58, 3
    s_and_b32 s74, s73, 7
    s_add_u32 s58, s58, s74
    s_lshr_b32 s59, s72, 1
    s_lshl_b32 s59, s59, 2
    s_lshr_b32 s73, s73, 3
    s_add_u32 s59, s59, s73
    s_add_u32 s60, s58, s59
    s_and_b32 s60, s60, 3
    s_lshl_b32 s60, s60, 1
    s_and_b32 s62, s61, 3
    s_and_b32 s63, s61, 1
    s_mov_b32 s80, 0xffff
    s_mov_b32 s81, 0xffff
    s_cmp_ge_u32 s61, 4
    s_cbranch_scc1 L_bwave
    v_bfe_u32 v2, v1, 3, 2
    v_lshlrev_b32 v2, 10, v2
    v_and_b32 v3, 7, v1
    v_lshl_add_u32 v2, v3, 7, v2
    s_lshl_b32 s72, s62, 12
    v_add_u32 v2, s72, v2
    v_bfe_u32 v3, v1, 1, 3
    v_lshrrev_b32 v4, 5, v1
    v_xor_b32 v3, v3, v4
    v_xor_b32 v4, 0, v3
    v_lshl_add_u32 v4, v4, 4, v2
    v_add_u32 v8, 49152, v4
    v_xor_b32 v5, 2, v3
    v_lshl_add_u32 v5, v5, 4, v2
    v_add_u32 v9, 49152, v5
    v_xor_b32 v6, 4, v3
    v_lshl_add_u32 v6, v6, 4, v2
    v_add_u32 v10, 49152, v6
    v_xor_b32 v7, 6, v3
    v_lshl_add_u32 v7, v7, 4, v2
    v_add_u32 v11, 49152, v7
    v_lshrrev_b32 v12, 5, v1
    v_lshlrev_b32 v12, 9, v12
    v_bfe_u32 v2, v1, 2, 2
    v_lshl_add_u32 v12, v2, 6, v12
    v_bfe_u32 v2, v1, 4, 1
    v_lshl_add_u32 v12, v2, 5, v12
    v_and_b32 v2, 3, v1
    v_lshl_add_u32 v12, v2, 3, v12
    v_add_u32 v13, 49152, v12
    s_waitcnt lgkmcnt(0)
    s_load_dwordx2 s[56:57], s[52:53], 0
    s_cmp_lg_u32 s61, 0
    s_cbranch_scc1 L_nomisc_1
    v_lshlrev_b32 v2, 4, v1
    s_mov_b32 m0, 162816
    v_mov_b32 v3, 0
    buffer_load_dwordx4 v2, s[44:47], 0 offen lds
    v_lshlrev_b32 v2, 2, v1
    v_add_u32 v2, 161792, v2
    s_mov_b64 exec, 0xffff
    ds_write_b32 v2, v3
    s_mov_b64 exec, -1
    s_waitcnt vmcnt(0)
L_nomisc_1:
    v_and_b32 v2, 0x33, v1
    v_bfe_u32 v3, v1, 2, 1
    v_lshl_add_u32 v2, v3, 3, v2
    v_bfe_u32 v3, v1, 3, 1
    v_lshl_add_u32 v2, v3, 2, v2
    v_lshlrev_b32 v14, 4, v2
    v_and_b32 v15, 15, v1
    v_lshrrev_b32 v2, 5, v1
    v_lshl_add_u32 v15, v2, 4, v15
    v_lshlrev_b32 v15, 4, v15
    v_add_u32 v15, 1024, v15
    s_lshl_b32 s73, s62, 4
    s_add_u32 s73, s73, s59
    s_lshl_b32 s74, s58, 18
    s_lshl_b32 s64, s73, 11
    s_add_u32 s64, s64, s74
    s_add_u32 s64, s64, 1048576
    s_add_u32 s65, s64, 131072
    s_lshl_b32 s66, s73, 3
    s_lshl_b32 s74, s58, 9
    s_add_u32 s66, s66, s74
    s_add_u32 s66, s66, 4096
    s_lshl_b32 s75, s62, 12
    s_add_u32 s75, s75, 139264
    v_bfe_u32 v2, v1, 4, 1
    v_lshl_add_u32 v96, v2, 17, v15
    v_lshl_add_u32 v98, v2, 11, v15
    v_add_u32 v97, s75, v14
    v_add_u32 v98, s75, v98
    v_mov_b32 v125, 0xdddddddd
    v_mov_b32 v56, 0
    v_mov_b32 v57, 0
    v_mov_b32 v58, 0
    v_mov_b32 v59, 0
    v_mov_b32 v124, 0
    s_mov_b32 exec_lo, 0x110000
    s_mov_b32 exec_hi, 0x110000
    v_mov_b32 v124, 0x3f803f80
    s_mov_b64 exec, -1
    v_accvgpr_write_b32 a84, v124
    v_accvgpr_write_b32 a85, v124
    v_accvgpr_write_b32 a86, v124
    v_accvgpr_write_b32 a87, v124
    v_accvgpr_write_b32 a88, v124
    v_accvgpr_write_b32 a89, v124
    v_accvgpr_write_b32 a90, v124
    v_accvgpr_write_b32 a91, v124
    v_accvgpr_write_b32 a92, v124
    v_accvgpr_write_b32 a93, v124
    v_accvgpr_write_b32 a94, v124
    v_accvgpr_write_b32 a95, v124
    v_accvgpr_write_b32 a96, v124
    v_accvgpr_write_b32 a97, v124
    v_accvgpr_write_b32 a98, v124
    v_accvgpr_write_b32 a99, v124
    v_accvgpr_write_b32 a100, v124
    v_accvgpr_write_b32 a101, v124
    v_accvgpr_write_b32 a102, v124
    v_accvgpr_write_b32 a103, v124
    v_accvgpr_write_b32 a104, v124
    v_accvgpr_write_b32 a105, v124
    v_accvgpr_write_b32 a106, v124
    v_accvgpr_write_b32 a107, v124
    v_accvgpr_write_b32 a108, v124
    v_accvgpr_write_b32 a109, v124
    v_accvgpr_write_b32 a110, v124
    v_accvgpr_write_b32 a111, v124
    v_accvgpr_write_b32 a112, v124
    v_accvgpr_write_b32 a113, v124
    v_accvgpr_write_b32 a114, v124
    v_accvgpr_write_b32 a115, v124
    v_accvgpr_write_b32 a116, v124
    v_accvgpr_write_b32 a117, v124
    v_accvgpr_write_b32 a118, v124
    v_accvgpr_write_b32 a119, v124
    v_accvgpr_write_b32 a120, v124
    v_accvgpr_write_b32 a121, v124
    v_accvgpr_write_b32 a122, v124
    v_accvgpr_write_b32 a123, v124
    v_mfma_f32_32x32x16_bf16 a[0:15], v[56:59], v[56:59], 0
    v_mfma_f32_32x32x16_bf16 a[16:31], v[56:59], v[56:59], 0
    v_mfma_f32_32x32x16_bf16 a[32:47], v[56:59], v[56:59], 0
    v_mfma_f32_32x32x16_bf16 a[48:63], v[56:59], v[56:59], 0
    s_lshr_b32 s73, s61, 1
    s_lshl_b32 s73, s73, 15
    s_lshl_b32 s74, s58, 18
    s_add_u32 s73, s73, s74
    s_lshl_b32 s74, s63, 17
    s_add_u32 s73, s73, s74
    s_add_u32 s73, s73, 1048576
    v_lshlrev_b32 v126, 4, v1
    v_add_u32 v126, s73, v126
    v_add_u32 v127, s73, v15
    s_mov_b32 s8, 0x76543210
    s_mov_b32 s9, 0xfedcba98
    s_lshl_b32 s73, s59, 2
    s_add_u32 s73, s73, 4
    s_sub_u32 s74, 64, s73
    s_lshr_b64 s[14:15], s[8:9], s73
    s_lshl_b64 s[8:9], s[8:9], s74
    s_or_b64 s[14:15], s[14:15], s[8:9]
    s_waitcnt lgkmcnt(0)
    s_add_u32 s56, s56, 1
    s_addc_u32 s57, s57, 0
    s_barrier
    ds_read_b128 v[16:19], v4 offset:0
    ds_read_b64_tr_b16 v[32:33], v12 offset:16384
    ds_read_b64_tr_b16 v[34:35], v12 offset:16640
    ds_read_b64_tr_b16 v[48:49], v12 offset:20480
    ds_read_b64_tr_b16 v[50:51], v12 offset:20736
    ds_read_b128 v[20:23], v5 offset:0
    ds_read_b64_tr_b16 v[36:37], v12 offset:17408
    ds_read_b64_tr_b16 v[38:39], v12 offset:17664
    ds_read_b64_tr_b16 v[52:53], v12 offset:21504
    ds_read_b64_tr_b16 v[54:55], v12 offset:21760
    ds_read_b128 v[24:27], v6 offset:0
    ds_read_b64_tr_b16 v[40:41], v12 offset:18432
    ds_read_b64_tr_b16 v[42:43], v12 offset:18688
    ds_read_b64_tr_b16 v[56:57], v12 offset:22528
    ds_read_b64_tr_b16 v[58:59], v12 offset:22784
    s_waitcnt lgkmcnt(10)
    v_mfma_f32_32x32x16_bf16 v[64:79], v[32:35], v[16:19], 0
    v_mfma_f32_32x32x16_bf16 v[80:95], v[16:19], v[48:51], 0
    ds_read_b128 v[28:31], v7 offset:0
    ds_read_b64_tr_b16 v[44:45], v12 offset:19456
    ds_read_b64_tr_b16 v[46:47], v12 offset:19712
    ds_read_b64_tr_b16 v[60:61], v12 offset:23552
    ds_read_b64_tr_b16 v[62:63], v12 offset:23808
    s_waitcnt lgkmcnt(10)
    v_mfma_f32_32x32x16_bf16 v[64:79], v[36:39], v[20:23], v[64:79]
    v_mfma_f32_32x32x16_bf16 v[80:95], v[20:23], v[52:55], v[80:95]
    s_waitcnt lgkmcnt(5)
    v_mfma_f32_32x32x16_bf16 v[64:79], v[40:43], v[24:27], v[64:79]
    v_mfma_f32_32x32x16_bf16 v[80:95], v[24:27], v[56:59], v[80:95]
    s_waitcnt lgkmcnt(0)
    v_mfma_f32_32x32x16_bf16 v[64:79], v[44:47], v[28:31], v[64:79]
    v_mfma_f32_32x32x16_bf16 v[80:95], v[28:31], v[60:63], v[80:95]
    s_barrier
    ds_read_b128 v[16:19], v4 offset:24576
    ds_read_b64_tr_b16 v[32:33], v12 offset:40960
    ds_read_b64_tr_b16 v[34:35], v12 offset:41216
    ds_read_b64_tr_b16 v[48:49], v12 offset:45056
    ds_read_b64_tr_b16 v[50:51], v12 offset:45312
    ds_read_b128 v[20:23], v5 offset:24576
    ds_read_b64_tr_b16 v[36:37], v12 offset:41984
    ds_read_b64_tr_b16 v[38:39], v12 offset:42240
    ds_read_b64_tr_b16 v[52:53], v12 offset:46080
    ds_read_b64_tr_b16 v[54:55], v12 offset:46336
    ds_read_b128 v[24:27], v6 offset:24576
    ds_read_b64_tr_b16 v[40:41], v12 offset:43008
    ds_read_b64_tr_b16 v[42:43], v12 offset:43264
    ds_read_b64_tr_b16 v[56:57], v12 offset:47104
    ds_read_b64_tr_b16 v[58:59], v12 offset:47360
    s_waitcnt lgkmcnt(10)
    v_mfma_f32_32x32x16_bf16 v[64:79], v[32:35], v[16:19], v[64:79]
    v_mfma_f32_32x32x16_bf16 v[80:95], v[16:19], v[48:51], v[80:95]
    ds_read_b128 v[28:31], v7 offset:24576
    ds_read_b64_tr_b16 v[44:45], v12 offset:44032
    ds_read_b64_tr_b16 v[46:47], v12 offset:44288
    ds_read_b64_tr_b16 v[60:61], v12 offset:48128
    ds_read_b64_tr_b16 v[62:63], v12 offset:48384
    s_waitcnt lgkmcnt(10)
    v_mfma_f32_32x32x16_bf16 v[64:79], v[36:39], v[20:23], v[64:79]
    v_mfma_f32_32x32x16_bf16 v[80:95], v[20:23], v[52:55], v[80:95]
    s_waitcnt lgkmcnt(5)
    v_mfma_f32_32x32x16_bf16 v[64:79], v[40:43], v[24:27], v[64:79]
    v_mfma_f32_32x32x16_bf16 v[80:95], v[24:27], v[56:59], v[80:95]
    s_waitcnt lgkmcnt(0)
    v_mfma_f32_32x32x16_bf16 v[64:79], v[44:47], v[28:31], v[64:79]
    v_mfma_f32_32x32x16_bf16 v[80:95], v[28:31], v[60:63], v[80:95]
    s_barrier
    ds_read_b128 v[16:19], v8 offset:0
    ds_read_b64_tr_b16 v[32:33], v13 offset:16384
    ds_read_b64_tr_b16 v[34:35], v13 offset:16640
    ds_read_b64_tr_b16 v[48:49], v13 offset:20480
    ds_read_b64_tr_b16 v[50:51], v13 offset:20736
    ds_read_b128 v[20:23], v9 offset:0
    ds_read_b64_tr_b16 v[36:37], v13 offset:17408
    ds_read_b64_tr_b16 v[38:39], v13 offset:17664
    ds_read_b64_tr_b16 v[52:53], v13 offset:21504
    ds_read_b64_tr_b16 v[54:55], v13 offset:21760
    ds_read_b128 v[24:27], v10 offset:0
    ds_read_b64_tr_b16 v[40:41], v13 offset:18432
    ds_read_b64_tr_b16 v[42:43], v13 offset:18688
    ds_read_b64_tr_b16 v[56:57], v13 offset:22528
    ds_read_b64_tr_b16 v[58:59], v13 offset:22784
    s_waitcnt lgkmcnt(10)
    v_mfma_f32_32x32x16_bf16 v[64:79], v[32:35], v[16:19], v[64:79]
    v_mfma_f32_32x32x16_bf16 v[80:95], v[16:19], v[48:51], v[80:95]
    ds_read_b128 v[28:31], v11 offset:0
    ds_read_b64_tr_b16 v[44:45], v13 offset:19456
    ds_read_b64_tr_b16 v[46:47], v13 offset:19712
    ds_read_b64_tr_b16 v[60:61], v13 offset:23552
    ds_read_b64_tr_b16 v[62:63], v13 offset:23808
    s_waitcnt lgkmcnt(10)
    v_mfma_f32_32x32x16_bf16 v[64:79], v[36:39], v[20:23], v[64:79]
    v_mfma_f32_32x32x16_bf16 v[80:95], v[20:23], v[52:55], v[80:95]
    s_waitcnt lgkmcnt(5)
    v_mfma_f32_32x32x16_bf16 v[64:79], v[40:43], v[24:27], v[64:79]
    v_mfma_f32_32x32x16_bf16 v[80:95], v[24:27], v[56:59], v[80:95]
    s_waitcnt lgkmcnt(0)
    v_mfma_f32_32x32x16_bf16 v[64:79], v[44:47], v[28:31], v[64:79]
    v_mfma_f32_32x32x16_bf16 v[80:95], v[28:31], v[60:63], v[80:95]
    s_barrier
    ds_read_b128 v[16:19], v8 offset:24576
    ds_read_b64_tr_b16 v[32:33], v13 offset:40960
    ds_read_b64_tr_b16 v[34:35], v13 offset:41216
    ds_read_b64_tr_b16 v[48:49], v13 offset:45056
    ds_read_b64_tr_b16 v[50:51], v13 offset:45312
    ds_read_b128 v[20:23], v9 offset:24576
    ds_read_b64_tr_b16 v[36:37], v13 offset:41984
    ds_read_b64_tr_b16 v[38:39], v13 offset:42240
    ds_read_b64_tr_b16 v[52:53], v13 offset:46080
    ds_read_b64_tr_b16 v[54:55], v13 offset:46336
    ds_read_b128 v[24:27], v10 offset:24576
    ds_read_b64_tr_b16 v[40:41], v13 offset:43008
    ds_read_b64_tr_b16 v[42:43], v13 offset:43264
    ds_read_b64_tr_b16 v[56:57], v13 offset:47104
    ds_read_b64_tr_b16 v[58:59], v13 offset:47360
    s_waitcnt lgkmcnt(10)
    v_mfma_f32_32x32x16_bf16 v[64:79], v[32:35], v[16:19], v[64:79]
    v_mfma_f32_32x32x16_bf16 v[80:95], v[16:19], v[48:51], v[80:95]
    ds_read_b128 v[28:31], v11 offset:24576
    ds_read_b64_tr_b16 v[44:45], v13 offset:44032
    ds_read_b64_tr_b16 v[46:47], v13 offset:44288
    ds_read_b64_tr_b16 v[60:61], v13 offset:48128
    ds_read_b64_tr_b16 v[62:63], v13 offset:48384
    s_waitcnt lgkmcnt(10)
    v_mfma_f32_32x32x16_bf16 v[64:79], v[36:39], v[20:23], v[64:79]
    v_mfma_f32_32x32x16_bf16 v[80:95], v[20:23], v[52:55], v[80:95]
    s_waitcnt lgkmcnt(5)
    v_mfma_f32_32x32x16_bf16 v[64:79], v[40:43], v[24:27], v[64:79]
    v_mfma_f32_32x32x16_bf16 v[80:95], v[24:27], v[56:59], v[80:95]
    s_waitcnt lgkmcnt(0)
    v_mfma_f32_32x32x16_bf16 v[64:79], v[44:47], v[28:31], v[64:79]
    v_mfma_f32_32x32x16_bf16 v[80:95], v[28:31], v[60:63], v[80:95]
    s_barrier
    ds_read_b128 v[16:19], v4 offset:0
    ds_read_b64_tr_b16 v[32:33], v12 offset:16384
    ds_read_b64_tr_b16 v[34:35], v12 offset:16640
    ds_read_b64_tr_b16 v[48:49], v12 offset:20480
    ds_read_b64_tr_b16 v[50:51], v12 offset:20736
    ds_read_b128 v[20:23], v5 offset:0
    ds_read_b64_tr_b16 v[36:37], v12 offset:17408
    ds_read_b64_tr_b16 v[38:39], v12 offset:17664
    ds_read_b64_tr_b16 v[52:53], v12 offset:21504
    ds_read_b64_tr_b16 v[54:55], v12 offset:21760
    ds_read_b128 v[24:27], v6 offset:0
    ds_read_b64_tr_b16 v[40:41], v12 offset:18432
    ds_read_b64_tr_b16 v[42:43], v12 offset:18688
    ds_read_b64_tr_b16 v[56:57], v12 offset:22528
    ds_read_b64_tr_b16 v[58:59], v12 offset:22784
    s_waitcnt lgkmcnt(10)
    v_mfma_f32_32x32x16_bf16 v[64:79], v[32:35], v[16:19], v[64:79]
    v_mfma_f32_32x32x16_bf16 v[80:95], v[16:19], v[48:51], v[80:95]
    ds_read_b128 v[28:31], v7 offset:0
    ds_read_b64_tr_b16 v[44:45], v12 offset:19456
    ds_read_b64_tr_b16 v[46:47], v12 offset:19712
    ds_read_b64_tr_b16 v[60:61], v12 offset:23552
    ds_read_b64_tr_b16 v[62:63], v12 offset:23808
    s_waitcnt lgkmcnt(10)
    v_mfma_f32_32x32x16_bf16 v[64:79], v[36:39], v[20:23], v[64:79]
    v_mfma_f32_32x32x16_bf16 v[80:95], v[20:23], v[52:55], v[80:95]
    s_waitcnt lgkmcnt(5)
    v_mfma_f32_32x32x16_bf16 v[64:79], v[40:43], v[24:27], v[64:79]
    v_mfma_f32_32x32x16_bf16 v[80:95], v[24:27], v[56:59], v[80:95]
    s_waitcnt lgkmcnt(0)
    v_mfma_f32_32x32x16_bf16 v[64:79], v[44:47], v[28:31], v[64:79]
    v_mfma_f32_32x32x16_bf16 v[80:95], v[28:31], v[60:63], v[80:95]
    s_barrier
    ds_read_b128 v[16:19], v4 offset:24576
    ds_read_b64_tr_b16 v[32:33], v12 offset:40960
    ds_read_b64_tr_b16 v[34:35], v12 offset:41216
    ds_read_b64_tr_b16 v[48:49], v12 offset:45056
    ds_read_b64_tr_b16 v[50:51], v12 offset:45312
    ds_read_b128 v[20:23], v5 offset:24576
    ds_read_b64_tr_b16 v[36:37], v12 offset:41984
    ds_read_b64_tr_b16 v[38:39], v12 offset:42240
    ds_read_b64_tr_b16 v[52:53], v12 offset:46080
    ds_read_b64_tr_b16 v[54:55], v12 offset:46336
    ds_read_b128 v[24:27], v6 offset:24576
    ds_read_b64_tr_b16 v[40:41], v12 offset:43008
    ds_read_b64_tr_b16 v[42:43], v12 offset:43264
    ds_read_b64_tr_b16 v[56:57], v12 offset:47104
    ds_read_b64_tr_b16 v[58:59], v12 offset:47360
    s_waitcnt lgkmcnt(10)
    v_mfma_f32_32x32x16_bf16 v[64:79], v[32:35], v[16:19], v[64:79]
    v_mfma_f32_32x32x16_bf16 v[80:95], v[16:19], v[48:51], v[80:95]
    ds_read_b128 v[28:31], v7 offset:24576
    ds_read_b64_tr_b16 v[44:45], v12 offset:44032
    ds_read_b64_tr_b16 v[46:47], v12 offset:44288
    ds_read_b64_tr_b16 v[60:61], v12 offset:48128
    ds_read_b64_tr_b16 v[62:63], v12 offset:48384
    s_waitcnt lgkmcnt(10)
    v_mfma_f32_32x32x16_bf16 v[64:79], v[36:39], v[20:23], v[64:79]
    v_mfma_f32_32x32x16_bf16 v[80:95], v[20:23], v[52:55], v[80:95]
    s_waitcnt lgkmcnt(5)
    v_mfma_f32_32x32x16_bf16 v[64:79], v[40:43], v[24:27], v[64:79]
    v_mfma_f32_32x32x16_bf16 v[80:95], v[24:27], v[56:59], v[80:95]
    s_waitcnt lgkmcnt(0)
    v_mfma_f32_32x32x16_bf16 v[64:79], v[44:47], v[28:31], v[64:79]
    v_mfma_f32_32x32x16_bf16 v[80:95], v[28:31], v[60:63], v[80:95]
    s_barrier
    ds_read_b128 v[16:19], v8 offset:0
    ds_read_b64_tr_b16 v[32:33], v13 offset:16384
    ds_read_b64_tr_b16 v[34:35], v13 offset:16640
    ds_read_b64_tr_b16 v[48:49], v13 offset:20480
    ds_read_b64_tr_b16 v[50:51], v13 offset:20736
    ds_read_b128 v[20:23], v9 offset:0
    ds_read_b64_tr_b16 v[36:37], v13 offset:17408
    ds_read_b64_tr_b16 v[38:39], v13 offset:17664
    ds_read_b64_tr_b16 v[52:53], v13 offset:21504
    ds_read_b64_tr_b16 v[54:55], v13 offset:21760
    ds_read_b128 v[24:27], v10 offset:0
    ds_read_b64_tr_b16 v[40:41], v13 offset:18432
    ds_read_b64_tr_b16 v[42:43], v13 offset:18688
    ds_read_b64_tr_b16 v[56:57], v13 offset:22528
    ds_read_b64_tr_b16 v[58:59], v13 offset:22784
    s_waitcnt lgkmcnt(10)
    v_mfma_f32_32x32x16_bf16 v[64:79], v[32:35], v[16:19], v[64:79]
    v_mfma_f32_32x32x16_bf16 v[80:95], v[16:19], v[48:51], v[80:95]
    ds_read_b128 v[28:31], v11 offset:0
    ds_read_b64_tr_b16 v[44:45], v13 offset:19456
    ds_read_b64_tr_b16 v[46:47], v13 offset:19712
    ds_read_b64_tr_b16 v[60:61], v13 offset:23552
    ds_read_b64_tr_b16 v[62:63], v13 offset:23808
    s_waitcnt lgkmcnt(10)
    v_mfma_f32_32x32x16_bf16 v[64:79], v[36:39], v[20:23], v[64:79]
    v_mfma_f32_32x32x16_bf16 v[80:95], v[20:23], v[52:55], v[80:95]
    s_waitcnt lgkmcnt(5)
    v_mfma_f32_32x32x16_bf16 v[64:79], v[40:43], v[24:27], v[64:79]
    v_mfma_f32_32x32x16_bf16 v[80:95], v[24:27], v[56:59], v[80:95]
    s_waitcnt lgkmcnt(0)
    v_mfma_f32_32x32x16_bf16 v[64:79], v[44:47], v[28:31], v[64:79]
    v_mfma_f32_32x32x16_bf16 v[80:95], v[28:31], v[60:63], v[80:95]
    s_barrier
    ds_read_b128 v[16:19], v8 offset:24576
    ds_read_b64_tr_b16 v[32:33], v13 offset:40960
    ds_read_b64_tr_b16 v[34:35], v13 offset:41216
    ds_read_b64_tr_b16 v[48:49], v13 offset:45056
    ds_read_b64_tr_b16 v[50:51], v13 offset:45312
    ds_read_b128 v[20:23], v9 offset:24576
    ds_read_b64_tr_b16 v[36:37], v13 offset:41984
    ds_read_b64_tr_b16 v[38:39], v13 offset:42240
    ds_read_b64_tr_b16 v[52:53], v13 offset:46080
    ds_read_b64_tr_b16 v[54:55], v13 offset:46336
    ds_read_b128 v[24:27], v10 offset:24576
    ds_read_b64_tr_b16 v[40:41], v13 offset:43008
    ds_read_b64_tr_b16 v[42:43], v13 offset:43264
    ds_read_b64_tr_b16 v[56:57], v13 offset:47104
    ds_read_b64_tr_b16 v[58:59], v13 offset:47360
    s_waitcnt lgkmcnt(10)
    v_mfma_f32_32x32x16_bf16 v[64:79], v[32:35], v[16:19], v[64:79]
    v_mfma_f32_32x32x16_bf16 v[80:95], v[16:19], v[48:51], v[80:95]
    ds_read_b128 v[28:31], v11 offset:24576
    ds_read_b64_tr_b16 v[44:45], v13 offset:44032
    ds_read_b64_tr_b16 v[46:47], v13 offset:44288
    ds_read_b64_tr_b16 v[60:61], v13 offset:48128
    ds_read_b64_tr_b16 v[62:63], v13 offset:48384
    s_waitcnt lgkmcnt(10)
    v_mfma_f32_32x32x16_bf16 v[64:79], v[36:39], v[20:23], v[64:79]
    v_mfma_f32_32x32x16_bf16 v[80:95], v[20:23], v[52:55], v[80:95]
    s_waitcnt lgkmcnt(5)
    v_mfma_f32_32x32x16_bf16 v[64:79], v[40:43], v[24:27], v[64:79]
    v_mfma_f32_32x32x16_bf16 v[80:95], v[24:27], v[56:59], v[80:95]
    s_waitcnt lgkmcnt(0)
    v_mfma_f32_32x32x16_bf16 v[64:79], v[44:47], v[28:31], v[64:79]
    v_mfma_f32_32x32x16_bf16 v[80:95], v[28:31], v[60:63], v[80:95]
    s_nop 10
    v_cvt_pk_bf16_f32 v48, v64, v65
    v_cvt_pk_bf16_f32 v49, v66, v67
    v_cvt_pk_bf16_f32 v50, v68, v69
    v_cvt_pk_bf16_f32 v51, v70, v71
    v_cvt_pk_bf16_f32 v52, v72, v73
    v_cvt_pk_bf16_f32 v53, v74, v75
    v_cvt_pk_bf16_f32 v54, v76, v77
    v_cvt_pk_bf16_f32 v55, v78, v79
    buffer_store_dwordx4 v[48:51], v14, s[52:55], s64 offen sc1
    buffer_store_dwordx4 v[52:55], v14, s[52:55], s65 offen sc1
    v_cvt_pk_bf16_f32 v56, v80, v81
    v_cvt_pk_bf16_f32 v57, v82, v83
    v_cvt_pk_bf16_f32 v58, v84, v85
    v_cvt_pk_bf16_f32 v59, v86, v87
    v_cvt_pk_bf16_f32 v60, v88, v89
    v_cvt_pk_bf16_f32 v61, v90, v91
    v_cvt_pk_bf16_f32 v62, v92, v93
    v_cvt_pk_bf16_f32 v63, v94, v95
    buffer_store_dwordx4 v[56:59], v96, s[52:55], s64 offen sc1
    buffer_store_dwordx4 v[60:63], v96, s[52:55], s64 offen offset:512 sc1
    ds_write_b128 v97, v[48:51]
    ds_write_b128 v97, v[52:55] offset:2048
    ds_write_b128 v98, v[56:59]
    ds_write_b128 v98, v[60:63] offset:512
    v_mov_b32 v4, 161792
    v_mov_b32 v6, 0
    s_waitcnt lgkmcnt(0)
    v_mov_b32 v5, 1
    s_mov_b64 exec, 1
    ds_add_u32 v4, v5 offset:20
    s_mov_b64 exec, -1
    s_waitcnt vmcnt(0)
    v_mov_b32 v2, s56
    v_mov_b32 v3, s57
    s_mov_b64 exec, 0x1
    buffer_store_dwordx2 v[2:3], v6, s[52:55], s66 offen sc1
    s_mov_b64 exec, -1
    s_mov_b32 s7, 0
L_spin_2:
    ds_read_b32 v5, v4 offset:20
    s_waitcnt lgkmcnt(0)
    v_readfirstlane_b32 s72, v5
    s_add_u32 s7, s7, 1
    s_cmp_ge_u32 s72, 8
    s_cbranch_scc1 L_spun_3
    s_sleep 1
    s_cmp_lt_u32 s7, 65536
    s_cbranch_scc1 L_spin_2
L_spun_3:
    s_lshl_b32 s73, s63, 10
    s_add_u32 s73, s73, 131072
    v_lshlrev_b32 v2, 4, v1
    v_add_u32 v3, s73, v2
    ds_read_b128 v[16:19], v3 offset:0
    ds_read_b128 v[20:23], v3 offset:2048
    ds_read_b128 v[24:27], v3 offset:4096
    ds_read_b128 v[28:31], v3 offset:6144
    s_lshr_b32 s73, s61, 1
    s_lshl_b32 s73, s73, 12
    s_lshl_b32 s74, s63, 11
    s_add_u32 s73, s73, s74
    s_add_u32 s73, s73, 139264
    v_add_u32 v5, s73, v2
    v_add_u32 v3, s73, v15
    ds_read_b128 a[76:79], v5
    ds_read_b128 a[80:83], v5 offset:8192
    s_mov_b64 exec, s[80:81]
    ds_read_b128 a[108:111], v3
    ds_read_b128 a[112:115], v3 offset:512
    ds_read_b128 a[116:119], v3 offset:8192
    ds_read_b128 a[120:123], v3 offset:8704
    s_mov_b64 exec, -1
    s_waitcnt lgkmcnt(0)
    v_mfma_f32_32x32x16_bf16 v[32:47], a[76:79], v[16:19], 0
    v_mov_b32 v5, 1
    s_mov_b64 exec, 1
    ds_add_u32 v4, v5 offset:16
    s_mov_b64 exec, -1
    s_setprio 1
    s_lshl_b32 s73, s58, 9
    s_lshr_b32 s74, s61, 1
    s_lshl_b32 s74, s74, 7
    s_add_u32 s73, s73, s74
    s_add_u32 s73, s73, 4096
    v_lshlrev_b32 v3, 3, v1
    s_nop 1
    v_exp_f32 v32, v32
    v_exp_f32 v33, v33
    v_exp_f32 v34, v34
    v_exp_f32 v35, v35
    v_exp_f32 v36, v36
    v_mfma_f32_32x32x16_bf16 v[48:63], a[76:79], v[20:23], 0
    v_exp_f32 v37, v37
    v_exp_f32 v38, v38
    v_exp_f32 v39, v39
    v_exp_f32 v40, v40
    v_exp_f32 v41, v41
    v_smfmac_f32_32x32x32_bf16 a[0:15], a[108:111], v[32:39], v125
    v_exp_f32 v42, v42
    v_exp_f32 v43, v43
    v_exp_f32 v44, v44
    v_exp_f32 v45, v45
    v_exp_f32 v46, v46
    v_exp_f32 v47, v47
    v_exp_f32 v48, v48
    v_exp_f32 v49, v49
    v_smfmac_f32_32x32x32_bf16 a[0:15], a[112:115], v[40:47], v125
    v_exp_f32 v50, v50
    s_mov_b64 exec, 0xffff
    buffer_load_dwordx2 v[4:5], v3, s[52:55], s73 offen sc1
    s_mov_b64 exec, -1
    v_exp_f32 v51, v51
    v_exp_f32 v52, v52
    v_mfma_f32_32x32x16_bf16 v[32:47], a[76:79], v[24:27], 0
    v_exp_f32 v53, v53
    v_exp_f32 v54, v54
    v_exp_f32 v55, v55
    v_exp_f32 v56, v56
    v_exp_f32 v57, v57
    v_smfmac_f32_32x32x32_bf16 a[16:31], a[108:111], v[48:55], v125
    v_exp_f32 v58, v58
    v_exp_f32 v59, v59
    v_exp_f32 v60, v60
    v_exp_f32 v61, v61
    v_exp_f32 v62, v62
    v_exp_f32 v63, v63
    v_exp_f32 v32, v32
    v_exp_f32 v33, v33
    v_smfmac_f32_32x32x32_bf16 a[16:31], a[112:115], v[56:63], v125
    v_exp_f32 v34, v34
    v_exp_f32 v35, v35
    v_exp_f32 v36, v36
    v_mfma_f32_32x32x16_bf16 v[48:63], a[76:79], v[28:31], 0
    v_exp_f32 v37, v37
    v_exp_f32 v38, v38
    v_exp_f32 v39, v39
    v_exp_f32 v40, v40
    v_exp_f32 v41, v41
    v_smfmac_f32_32x32x32_bf16 a[32:47], a[108:111], v[32:39], v125
    v_exp_f32 v42, v42
    v_exp_f32 v43, v43
    v_exp_f32 v44, v44
    v_exp_f32 v45, v45
    v_exp_f32 v46, v46
    v_exp_f32 v47, v47
    v_exp_f32 v48, v48
    v_exp_f32 v49, v49
    v_smfmac_f32_32x32x32_bf16 a[32:47], a[112:115], v[40:47], v125
    v_exp_f32 v50, v50
    v_exp_f32 v51, v51
    v_exp_f32 v52, v52
    v_mfma_f32_32x32x16_bf16 v[32:47], a[80:83], v[16:19], 0
    v_exp_f32 v53, v53
    v_exp_f32 v54, v54
    v_exp_f32 v55, v55
    v_exp_f32 v56, v56
    v_exp_f32 v57, v57
    v_smfmac_f32_32x32x32_bf16 a[48:63], a[108:111], v[48:55], v125
    v_exp_f32 v58, v58
    v_exp_f32 v59, v59
    v_exp_f32 v60, v60
    v_exp_f32 v61, v61
    v_exp_f32 v62, v62
    v_exp_f32 v63, v63
    s_mov_b64 exec, 0xffff
    s_waitcnt vmcnt(0)
    v_cmp_ne_u64 vcc, s[56:57], v[4:5]
    s_mov_b64 exec, -1
    s_cmp_eq_u64 vcc, 0
    s_cbranch_scc1 L_kvrdy_4
    s_mov_b32 s7, 0
    s_mov_b32 exec_lo, 0xffff
    s_mov_b32 exec_hi, 0x0
L_poll_5:
    buffer_load_dwordx2 v[4:5], v3, s[52:55], s73 offen sc1
    s_waitcnt vmcnt(0)
    v_cmp_ne_u64 vcc, s[56:57], v[4:5]
    s_add_u32 s7, s7, 1
    s_cmp_eq_u64 vcc, 0
    s_cbranch_scc1 L_polled_6
    s_sleep 2
    s_cmp_lt_u32 s7, 65536
    s_cbranch_scc1 L_poll_5
L_polled_6:
    s_mov_b64 exec, -1
L_kvrdy_4:
    s_lshl_b32 s78, s14, 11
    s_and_b32 s78, s78, 0x7800
    buffer_load_dwordx4 a[64:67], v126, s[52:55], s78 offen sc1
    s_mov_b64 exec, s[80:81]
    buffer_load_dwordx4 a[84:87], v127, s[52:55], s78 offen sc1
    buffer_load_dwordx4 a[88:91], v127, s[52:55], s78 offen offset:512 sc1
    s_mov_b64 exec, -1
    s_lshl_b32 s78, s14, 7
    s_and_b32 s78, s78, 0x7800
    buffer_load_dwordx4 a[68:71], v126, s[52:55], s78 offen sc1
    s_mov_b64 exec, s[80:81]
    buffer_load_dwordx4 a[92:95], v127, s[52:55], s78 offen sc1
    buffer_load_dwordx4 a[96:99], v127, s[52:55], s78 offen offset:512 sc1
    s_mov_b64 exec, -1
    s_lshl_b32 s78, s14, 3
    s_and_b32 s78, s78, 0x7800
    buffer_load_dwordx4 a[72:75], v126, s[52:55], s78 offen sc1
    s_mov_b64 exec, s[80:81]
    buffer_load_dwordx4 a[100:103], v127, s[52:55], s78 offen sc1
    buffer_load_dwordx4 a[104:107], v127, s[52:55], s78 offen offset:512 sc1
    s_mov_b64 exec, -1
    v_exp_f32 v32, v32
    v_exp_f32 v33, v33
    v_smfmac_f32_32x32x32_bf16 a[48:63], a[112:115], v[56:63], v125
    v_exp_f32 v34, v34
    s_lshr_b32 s78, s14, 1
    s_and_b32 s78, s78, 0x7800
    buffer_load_dwordx4 a[76:79], v126, s[52:55], s78 offen sc1
    s_mov_b64 exec, s[80:81]
    buffer_load_dwordx4 a[108:111], v127, s[52:55], s78 offen sc1
    buffer_load_dwordx4 a[112:115], v127, s[52:55], s78 offen offset:512 sc1
    s_mov_b64 exec, -1
    s_lshr_b32 s78, s14, 5
    s_and_b32 s78, s78, 0x7800
    s_lshr_b64 s[14:15], s[14:15], 9
    v_exp_f32 v35, v35
    v_exp_f32 v36, v36
    v_mfma_f32_32x32x16_bf16 v[48:63], a[80:83], v[20:23], 0
    v_exp_f32 v37, v37
    v_exp_f32 v38, v38
    v_exp_f32 v39, v39
    v_exp_f32 v40, v40
    v_exp_f32 v41, v41
    v_smfmac_f32_32x32x32_bf16 a[0:15], a[116:119], v[32:39], v125
    v_exp_f32 v42, v42
    v_exp_f32 v43, v43
    v_exp_f32 v44, v44
    v_exp_f32 v45, v45
    v_exp_f32 v46, v46
    v_exp_f32 v47, v47
    v_exp_f32 v48, v48
    v_exp_f32 v49, v49
    v_smfmac_f32_32x32x32_bf16 a[0:15], a[120:123], v[40:47], v125
    v_exp_f32 v50, v50
    v_exp_f32 v51, v51
    v_exp_f32 v52, v52
    v_mfma_f32_32x32x16_bf16 v[32:47], a[80:83], v[24:27], 0
    v_exp_f32 v53, v53
    v_exp_f32 v54, v54
    v_exp_f32 v55, v55
    v_exp_f32 v56, v56
    v_exp_f32 v57, v57
    v_smfmac_f32_32x32x32_bf16 a[16:31], a[116:119], v[48:55], v125
    v_exp_f32 v58, v58
    v_exp_f32 v59, v59
    v_exp_f32 v60, v60
    v_exp_f32 v61, v61
    v_exp_f32 v62, v62
    v_exp_f32 v63, v63
    v_exp_f32 v32, v32
    v_exp_f32 v33, v33
    v_smfmac_f32_32x32x32_bf16 a[16:31], a[120:123], v[56:63], v125
    v_exp_f32 v34, v34
    v_exp_f32 v35, v35
    v_exp_f32 v36, v36
    v_mfma_f32_32x32x16_bf16 v[48:63], a[80:83], v[28:31], 0
    v_exp_f32 v37, v37
    v_exp_f32 v38, v38
    v_exp_f32 v39, v39
    v_exp_f32 v40, v40
    v_exp_f32 v41, v41
    v_smfmac_f32_32x32x32_bf16 a[32:47], a[116:119], v[32:39], v125
    v_exp_f32 v42, v42
    v_exp_f32 v43, v43
    v_exp_f32 v44, v44
    v_exp_f32 v45, v45
    v_exp_f32 v46, v46
    v_exp_f32 v47, v47
    v_exp_f32 v48, v48
    v_exp_f32 v49, v49
    v_smfmac_f32_32x32x32_bf16 a[32:47], a[120:123], v[40:47], v125
    v_exp_f32 v50, v50
    v_exp_f32 v51, v51
    v_exp_f32 v52, v52
    s_waitcnt vmcnt(9)
    v_mfma_f32_32x32x16_bf16 v[32:47], a[64:67], v[16:19], 0
    v_exp_f32 v53, v53
    v_exp_f32 v54, v54
    v_exp_f32 v55, v55
    v_exp_f32 v56, v56
    v_exp_f32 v57, v57
    v_smfmac_f32_32x32x32_bf16 a[48:63], a[116:119], v[48:55], v125
    v_exp_f32 v58, v58
    v_exp_f32 v59, v59
    v_exp_f32 v60, v60
    v_exp_f32 v61, v61
    v_exp_f32 v62, v62
    v_exp_f32 v63, v63
    s_mov_b32 s79, 3
    s_branch L_loop
L_bwave:
    s_setprio 3
    v_lshrrev_b32 v4, 3, v1
    v_lshrrev_b32 v5, 4, v1
    v_and_b32 v6, 7, v1
    v_xor_b32 v5, v5, v6
    v_lshlrev_b32 v4, 10, v4
    v_lshl_add_u32 v2, v5, 4, v4
    v_xor_b32 v3, 64, v2
    v_lshrrev_b32 v4, 2, v1
    v_and_b32 v5, 3, v1
    v_mul_u32_u24 v4, 3072, v4
    v_lshl_add_u32 v14, v5, 4, v4
    s_lshl_b32 s4, s62, 12
    s_lshl_b32 s5, s62, 10
    s_lshl_b32 s6, s59, 17
    s_lshl_b32 s73, s62, 15
    s_add_u32 s6, s6, s73
    s_mul_i32 s74, s62, 49152
    s_lshl_b32 s73, s58, 6
    s_add_u32 s74, s74, s73
    s_waitcnt lgkmcnt(0)
    s_add_u32 s73, s60, 0
    s_and_b32 s73, s73, 7
    s_mul_i32 s64, s73, 196608
    s_add_u32 s64, s64, s74
    s_lshl_b32 s73, s73, 7
    s_add_u32 s73, s73, s6
    s_add_u32 m0, s4, 0
    s_add_u32 s72, s73, 0
    buffer_load_dwordx4 v2, s[24:27], s72 offen lds
    s_add_u32 m0, s4, 1024
    s_add_u32 s72, s73, 8192
    buffer_load_dwordx4 v3, s[24:27], s72 offen lds
    s_add_u32 m0, s4, 2048
    s_add_u32 s72, s73, 16384
    buffer_load_dwordx4 v2, s[24:27], s72 offen lds
    s_add_u32 m0, s4, 3072
    s_add_u32 s72, s73, 24576
    buffer_load_dwordx4 v3, s[24:27], s72 offen lds
    s_add_u32 m0, s5, 16384
    s_add_u32 s72, s64, 1024
    buffer_load_dwordx4 v14, s[28:31], s72 offen lds
    s_add_u32 m0, s5, 20480
    s_add_u32 s72, s64, 2048
    buffer_load_dwordx4 v14, s[28:31], s72 offen lds
    s_load_dwordx2 s[56:57], s[52:53], 0
    s_add_u32 s73, s60, 1
    s_and_b32 s73, s73, 7
    s_mul_i32 s65, s73, 196608
    s_add_u32 s65, s65, s74
    s_lshl_b32 s73, s73, 7
    s_add_u32 s73, s73, s6
    s_add_u32 m0, s4, 24576
    s_add_u32 s72, s73, 0
    buffer_load_dwordx4 v2, s[24:27], s72 offen lds
    s_add_u32 m0, s4, 25600
    s_add_u32 s72, s73, 8192
    buffer_load_dwordx4 v3, s[24:27], s72 offen lds
    s_add_u32 m0, s4, 26624
    s_add_u32 s72, s73, 16384
    buffer_load_dwordx4 v2, s[24:27], s72 offen lds
    s_add_u32 m0, s4, 27648
    s_add_u32 s72, s73, 24576
    buffer_load_dwordx4 v3, s[24:27], s72 offen lds
    s_add_u32 m0, s5, 40960
    s_add_u32 s72, s65, 1024
    buffer_load_dwordx4 v14, s[28:31], s72 offen lds
    s_add_u32 m0, s5, 45056
    s_add_u32 s72, s65, 2048
    buffer_load_dwordx4 v14, s[28:31], s72 offen lds
    v_bfe_u32 v15, v1, 3, 2
    v_lshlrev_b32 v15, 10, v15
    v_and_b32 v16, 7, v1
    v_lshl_add_u32 v15, v16, 7, v15
    s_lshl_b32 s72, s62, 12
    v_add_u32 v15, s72, v15
    v_bfe_u32 v16, v1, 1, 3
    v_lshrrev_b32 v4, 5, v1
    v_xor_b32 v16, v16, v4
    v_xor_b32 v4, 0, v16
    v_lshl_add_u32 v4, v4, 4, v15
    v_add_u32 v8, 49152, v4
    v_xor_b32 v5, 2, v16
    v_lshl_add_u32 v5, v5, 4, v15
    v_add_u32 v9, 49152, v5
    v_xor_b32 v6, 4, v16
    v_lshl_add_u32 v6, v6, 4, v15
    v_add_u32 v10, 49152, v6
    v_xor_b32 v7, 6, v16
    v_lshl_add_u32 v7, v7, 4, v15
    v_add_u32 v11, 49152, v7
    v_lshrrev_b32 v12, 5, v1
    v_lshlrev_b32 v12, 9, v12
    v_bfe_u32 v15, v1, 2, 2
    v_lshl_add_u32 v12, v15, 6, v12
    v_bfe_u32 v15, v1, 4, 1
    v_lshl_add_u32 v12, v15, 5, v12
    v_and_b32 v15, 3, v1
    v_lshl_add_u32 v12, v15, 3, v12
    v_add_u32 v13, 49152, v12
    s_waitcnt lgkmcnt(0)
    s_add_u32 s56, s56, 1
    s_addc_u32 s57, s57, 0
    v_lshrrev_b32 v15, 5, v1
    v_lshlrev_b32 v15, 4, v15
    v_add_u32 v15, 162816, v15
    s_and_b32 s3, s58, 3
    s_sub_u32 s3, s3, s62
    s_waitcnt vmcnt(6) lgkmcnt(0)
    s_barrier
    s_cmp_lg_u32 s3, 0
    s_cbranch_scc1 L_nogate_7
    s_add_u32 s73, s60, 0
    s_and_b32 s73, s73, 7
    s_lshl_b32 s73, s73, 7
    v_add_u32 v16, s73, v15
    ds_read_b128 v[32:35], v16 offset:0
    ds_read_b128 v[36:39], v16 offset:32
    ds_read_b128 v[40:43], v16 offset:64
    ds_read_b128 v[44:47], v16 offset:96
L_nogate_7:
    ds_read_b128 a[0:3], v4 offset:0
    ds_read_b128 a[4:7], v5 offset:0
    ds_read_b128 a[8:11], v6 offset:0
    ds_read_b128 a[12:15], v7 offset:0
    s_add_u32 s73, s60, 2
    s_and_b32 s73, s73, 7
    s_mul_i32 s66, s73, 196608
    s_add_u32 s66, s66, s74
    s_lshl_b32 s73, s73, 7
    s_add_u32 s73, s73, s6
    s_add_u32 m0, s4, 49152
    s_add_u32 s72, s73, 0
    buffer_load_dwordx4 v2, s[24:27], s72 offen lds
    s_add_u32 m0, s4, 50176
    s_add_u32 s72, s73, 8192
    buffer_load_dwordx4 v3, s[24:27], s72 offen lds
    s_add_u32 m0, s4, 51200
    s_add_u32 s72, s73, 16384
    buffer_load_dwordx4 v2, s[24:27], s72 offen lds
    s_add_u32 m0, s4, 52224
    s_add_u32 s72, s73, 24576
    buffer_load_dwordx4 v3, s[24:27], s72 offen lds
    s_add_u32 m0, s5, 65536
    s_add_u32 s72, s66, 1024
    buffer_load_dwordx4 v14, s[28:31], s72 offen lds
    s_add_u32 m0, s5, 69632
    s_add_u32 s72, s66, 2048
    buffer_load_dwordx4 v14, s[28:31], s72 offen lds
    s_waitcnt vmcnt(6) lgkmcnt(0)
    s_barrier
    s_cmp_lg_u32 s3, 0
    s_cbranch_scc1 L_nogate_8
    v_mfma_f32_32x32x16_bf16 v[100:115], v[32:35], a[0:3], 0
    v_mfma_f32_32x32x16_bf16 v[100:115], v[36:39], a[4:7], v[100:115]
    v_mfma_f32_32x32x16_bf16 v[100:115], v[40:43], a[8:11], v[100:115]
    v_mfma_f32_32x32x16_bf16 v[100:115], v[44:47], a[12:15], v[100:115]
    s_add_u32 s73, s60, 1
    s_and_b32 s73, s73, 7
    s_lshl_b32 s73, s73, 7
    v_add_u32 v16, s73, v15
    ds_read_b128 v[32:35], v16 offset:0
    ds_read_b128 v[36:39], v16 offset:32
    ds_read_b128 v[40:43], v16 offset:64
    ds_read_b128 v[44:47], v16 offset:96
L_nogate_8:
    ds_read_b128 a[16:19], v4 offset:24576
    ds_read_b128 a[20:23], v5 offset:24576
    ds_read_b128 a[24:27], v6 offset:24576
    ds_read_b128 a[28:31], v7 offset:24576
    s_add_u32 s73, s60, 3
    s_and_b32 s73, s73, 7
    s_mul_i32 s67, s73, 196608
    s_add_u32 s67, s67, s74
    s_lshl_b32 s73, s73, 7
    s_add_u32 s73, s73, s6
    s_add_u32 m0, s4, 73728
    s_add_u32 s72, s73, 0
    buffer_load_dwordx4 v2, s[24:27], s72 offen lds
    s_add_u32 m0, s4, 74752
    s_add_u32 s72, s73, 8192
    buffer_load_dwordx4 v3, s[24:27], s72 offen lds
    s_add_u32 m0, s4, 75776
    s_add_u32 s72, s73, 16384
    buffer_load_dwordx4 v2, s[24:27], s72 offen lds
    s_add_u32 m0, s4, 76800
    s_add_u32 s72, s73, 24576
    buffer_load_dwordx4 v3, s[24:27], s72 offen lds
    s_add_u32 m0, s5, 90112
    s_add_u32 s72, s67, 1024
    buffer_load_dwordx4 v14, s[28:31], s72 offen lds
    s_add_u32 m0, s5, 94208
    s_add_u32 s72, s67, 2048
    buffer_load_dwordx4 v14, s[28:31], s72 offen lds
    s_waitcnt vmcnt(6) lgkmcnt(0)
    s_barrier
    s_cmp_lg_u32 s3, 0
    s_cbranch_scc1 L_nogate_9
    v_mfma_f32_32x32x16_bf16 v[100:115], v[32:35], a[16:19], v[100:115]
    v_mfma_f32_32x32x16_bf16 v[100:115], v[36:39], a[20:23], v[100:115]
    v_mfma_f32_32x32x16_bf16 v[100:115], v[40:43], a[24:27], v[100:115]
    v_mfma_f32_32x32x16_bf16 v[100:115], v[44:47], a[28:31], v[100:115]
    s_add_u32 s73, s60, 2
    s_and_b32 s73, s73, 7
    s_lshl_b32 s73, s73, 7
    v_add_u32 v16, s73, v15
    ds_read_b128 v[32:35], v16 offset:0
    ds_read_b128 v[36:39], v16 offset:32
    ds_read_b128 v[40:43], v16 offset:64
    ds_read_b128 v[44:47], v16 offset:96
L_nogate_9:
    ds_read_b128 a[32:35], v8 offset:0
    ds_read_b128 a[36:39], v9 offset:0
    ds_read_b128 a[40:43], v10 offset:0
    ds_read_b128 a[44:47], v11 offset:0
    s_add_u32 s73, s60, 4
    s_and_b32 s73, s73, 7
    s_mul_i32 s68, s73, 196608
    s_add_u32 s68, s68, s74
    s_lshl_b32 s73, s73, 7
    s_add_u32 s73, s73, s6
    s_add_u32 m0, s4, 0
    s_add_u32 s72, s73, 0
    buffer_load_dwordx4 v2, s[24:27], s72 offen lds
    s_add_u32 m0, s4, 1024
    s_add_u32 s72, s73, 8192
    buffer_load_dwordx4 v3, s[24:27], s72 offen lds
    s_add_u32 m0, s4, 2048
    s_add_u32 s72, s73, 16384
    buffer_load_dwordx4 v2, s[24:27], s72 offen lds
    s_add_u32 m0, s4, 3072
    s_add_u32 s72, s73, 24576
    buffer_load_dwordx4 v3, s[24:27], s72 offen lds
    s_add_u32 m0, s5, 16384
    s_add_u32 s72, s68, 1024
    buffer_load_dwordx4 v14, s[28:31], s72 offen lds
    s_add_u32 m0, s5, 20480
    s_add_u32 s72, s68, 2048
    buffer_load_dwordx4 v14, s[28:31], s72 offen lds
    s_waitcnt vmcnt(6) lgkmcnt(0)
    s_barrier
    s_cmp_lg_u32 s3, 0
    s_cbranch_scc1 L_nogate_10
    v_mfma_f32_32x32x16_bf16 v[100:115], v[32:35], a[32:35], v[100:115]
    v_mfma_f32_32x32x16_bf16 v[100:115], v[36:39], a[36:39], v[100:115]
    v_mfma_f32_32x32x16_bf16 v[100:115], v[40:43], a[40:43], v[100:115]
    v_mfma_f32_32x32x16_bf16 v[100:115], v[44:47], a[44:47], v[100:115]
    s_add_u32 s73, s60, 3
    s_and_b32 s73, s73, 7
    s_lshl_b32 s73, s73, 7
    v_add_u32 v16, s73, v15
    ds_read_b128 v[32:35], v16 offset:0
    ds_read_b128 v[36:39], v16 offset:32
    ds_read_b128 v[40:43], v16 offset:64
    ds_read_b128 v[44:47], v16 offset:96
L_nogate_10:
    ds_read_b128 a[48:51], v8 offset:24576
    ds_read_b128 a[52:55], v9 offset:24576
    ds_read_b128 a[56:59], v10 offset:24576
    ds_read_b128 a[60:63], v11 offset:24576
    s_add_u32 s73, s60, 5
    s_and_b32 s73, s73, 7
    s_mul_i32 s69, s73, 196608
    s_add_u32 s69, s69, s74
    s_lshl_b32 s73, s73, 7
    s_add_u32 s73, s73, s6
    s_add_u32 m0, s4, 24576
    s_add_u32 s72, s73, 0
    buffer_load_dwordx4 v2, s[24:27], s72 offen lds
    s_add_u32 m0, s4, 25600
    s_add_u32 s72, s73, 8192
    buffer_load_dwordx4 v3, s[24:27], s72 offen lds
    s_add_u32 m0, s4, 26624
    s_add_u32 s72, s73, 16384
    buffer_load_dwordx4 v2, s[24:27], s72 offen lds
    s_add_u32 m0, s4, 27648
    s_add_u32 s72, s73, 24576
    buffer_load_dwordx4 v3, s[24:27], s72 offen lds
    s_add_u32 m0, s5, 40960
    s_add_u32 s72, s69, 1024
    buffer_load_dwordx4 v14, s[28:31], s72 offen lds
    s_add_u32 m0, s5, 45056
    s_add_u32 s72, s69, 2048
    buffer_load_dwordx4 v14, s[28:31], s72 offen lds
    s_waitcnt vmcnt(6) lgkmcnt(0)
    s_barrier
    s_cmp_lg_u32 s3, 0
    s_cbranch_scc1 L_nogate_11
    v_mfma_f32_32x32x16_bf16 v[100:115], v[32:35], a[48:51], v[100:115]
    v_mfma_f32_32x32x16_bf16 v[100:115], v[36:39], a[52:55], v[100:115]
    v_mfma_f32_32x32x16_bf16 v[100:115], v[40:43], a[56:59], v[100:115]
    v_mfma_f32_32x32x16_bf16 v[100:115], v[44:47], a[60:63], v[100:115]
    s_add_u32 s73, s60, 4
    s_and_b32 s73, s73, 7
    s_lshl_b32 s73, s73, 7
    v_add_u32 v16, s73, v15
    ds_read_b128 v[32:35], v16 offset:0
    ds_read_b128 v[36:39], v16 offset:32
    ds_read_b128 v[40:43], v16 offset:64
    ds_read_b128 v[44:47], v16 offset:96
L_nogate_11:
    ds_read_b128 a[64:67], v4 offset:0
    ds_read_b128 a[68:71], v5 offset:0
    ds_read_b128 a[72:75], v6 offset:0
    ds_read_b128 a[76:79], v7 offset:0
    s_add_u32 s73, s60, 6
    s_and_b32 s73, s73, 7
    s_mul_i32 s70, s73, 196608
    s_add_u32 s70, s70, s74
    s_lshl_b32 s73, s73, 7
    s_add_u32 s73, s73, s6
    s_add_u32 m0, s4, 49152
    s_add_u32 s72, s73, 0
    buffer_load_dwordx4 v2, s[24:27], s72 offen lds
    s_add_u32 m0, s4, 50176
    s_add_u32 s72, s73, 8192
    buffer_load_dwordx4 v3, s[24:27], s72 offen lds
    s_add_u32 m0, s4, 51200
    s_add_u32 s72, s73, 16384
    buffer_load_dwordx4 v2, s[24:27], s72 offen lds
    s_add_u32 m0, s4, 52224
    s_add_u32 s72, s73, 24576
    buffer_load_dwordx4 v3, s[24:27], s72 offen lds
    s_add_u32 m0, s5, 65536
    s_add_u32 s72, s70, 1024
    buffer_load_dwordx4 v14, s[28:31], s72 offen lds
    s_add_u32 m0, s5, 69632
    s_add_u32 s72, s70, 2048
    buffer_load_dwordx4 v14, s[28:31], s72 offen lds
    s_waitcnt vmcnt(6) lgkmcnt(0)
    s_barrier
    s_cmp_lg_u32 s3, 0
    s_cbranch_scc1 L_nogate_12
    v_mfma_f32_32x32x16_bf16 v[100:115], v[32:35], a[64:67], v[100:115]
    v_mfma_f32_32x32x16_bf16 v[100:115], v[36:39], a[68:71], v[100:115]
    v_mfma_f32_32x32x16_bf16 v[100:115], v[40:43], a[72:75], v[100:115]
    v_mfma_f32_32x32x16_bf16 v[100:115], v[44:47], a[76:79], v[100:115]
    s_add_u32 s73, s60, 5
    s_and_b32 s73, s73, 7
    s_lshl_b32 s73, s73, 7
    v_add_u32 v16, s73, v15
    ds_read_b128 v[32:35], v16 offset:0
    ds_read_b128 v[36:39], v16 offset:32
    ds_read_b128 v[40:43], v16 offset:64
    ds_read_b128 v[44:47], v16 offset:96
L_nogate_12:
    ds_read_b128 a[80:83], v4 offset:24576
    ds_read_b128 a[84:87], v5 offset:24576
    ds_read_b128 a[88:91], v6 offset:24576
    ds_read_b128 a[92:95], v7 offset:24576
    s_add_u32 s73, s60, 7
    s_and_b32 s73, s73, 7
    s_mul_i32 s71, s73, 196608
    s_add_u32 s71, s71, s74
    s_lshl_b32 s73, s73, 7
    s_add_u32 s73, s73, s6
    s_add_u32 m0, s4, 73728
    s_add_u32 s72, s73, 0
    buffer_load_dwordx4 v2, s[24:27], s72 offen lds
    s_add_u32 m0, s4, 74752
    s_add_u32 s72, s73, 8192
    buffer_load_dwordx4 v3, s[24:27], s72 offen lds
    s_add_u32 m0, s4, 75776
    s_add_u32 s72, s73, 16384
    buffer_load_dwordx4 v2, s[24:27], s72 offen lds
    s_add_u32 m0, s4, 76800
    s_add_u32 s72, s73, 24576
    buffer_load_dwordx4 v3, s[24:27], s72 offen lds
    s_add_u32 m0, s5, 90112
    s_add_u32 s72, s71, 1024
    buffer_load_dwordx4 v14, s[28:31], s72 offen lds
    s_add_u32 m0, s5, 94208
    s_add_u32 s72, s71, 2048
    buffer_load_dwordx4 v14, s[28:31], s72 offen lds
    s_waitcnt vmcnt(6) lgkmcnt(0)
    s_barrier
    s_cmp_lg_u32 s3, 0
    s_cbranch_scc1 L_nogate_13
    v_mfma_f32_32x32x16_bf16 v[100:115], v[32:35], a[80:83], v[100:115]
    v_mfma_f32_32x32x16_bf16 v[100:115], v[36:39], a[84:87], v[100:115]
    v_mfma_f32_32x32x16_bf16 v[100:115], v[40:43], a[88:91], v[100:115]
    v_mfma_f32_32x32x16_bf16 v[100:115], v[44:47], a[92:95], v[100:115]
    s_add_u32 s73, s60, 6
    s_and_b32 s73, s73, 7
    s_lshl_b32 s73, s73, 7
    v_add_u32 v16, s73, v15
    ds_read_b128 v[32:35], v16 offset:0
    ds_read_b128 v[36:39], v16 offset:32
    ds_read_b128 v[40:43], v16 offset:64
    ds_read_b128 v[44:47], v16 offset:96
L_nogate_13:
    ds_read_b128 a[96:99], v8 offset:0
    ds_read_b128 a[100:103], v9 offset:0
    ds_read_b128 a[104:107], v10 offset:0
    ds_read_b128 a[108:111], v11 offset:0
    s_add_u32 m0, s5, 98304
    s_add_u32 s72, s64, 0
    buffer_load_dwordx4 v14, s[28:31], s72 offen lds
    s_add_u32 m0, s5, 102400
    s_add_u32 s72, s65, 0
    buffer_load_dwordx4 v14, s[28:31], s72 offen lds
    s_add_u32 m0, s5, 106496
    s_add_u32 s72, s66, 0
    buffer_load_dwordx4 v14, s[28:31], s72 offen lds
    s_add_u32 m0, s5, 110592
    s_add_u32 s72, s67, 0
    buffer_load_dwordx4 v14, s[28:31], s72 offen lds
    s_waitcnt vmcnt(4) lgkmcnt(0)
    s_barrier
    s_cmp_lg_u32 s3, 0
    s_cbranch_scc1 L_nogate_14
    v_mfma_f32_32x32x16_bf16 v[100:115], v[32:35], a[96:99], v[100:115]
    v_mfma_f32_32x32x16_bf16 v[100:115], v[36:39], a[100:103], v[100:115]
    v_mfma_f32_32x32x16_bf16 v[100:115], v[40:43], a[104:107], v[100:115]
    v_mfma_f32_32x32x16_bf16 v[100:115], v[44:47], a[108:111], v[100:115]
    s_add_u32 s73, s60, 7
    s_and_b32 s73, s73, 7
    s_lshl_b32 s73, s73, 7
    v_add_u32 v16, s73, v15
    ds_read_b128 v[32:35], v16 offset:0
    ds_read_b128 v[36:39], v16 offset:32
    ds_read_b128 v[40:43], v16 offset:64
    ds_read_b128 v[44:47], v16 offset:96
L_nogate_14:
    ds_read_b128 a[112:115], v8 offset:24576
    ds_read_b128 a[116:119], v9 offset:24576
    ds_read_b128 a[120:123], v10 offset:24576
    ds_read_b128 a[124:127], v11 offset:24576
    s_add_u32 m0, s5, 114688
    s_add_u32 s72, s68, 0
    buffer_load_dwordx4 v14, s[28:31], s72 offen lds
    s_add_u32 m0, s5, 118784
    s_add_u32 s72, s69, 0
    buffer_load_dwordx4 v14, s[28:31], s72 offen lds
    s_add_u32 m0, s5, 122880
    s_add_u32 s72, s70, 0
    buffer_load_dwordx4 v14, s[28:31], s72 offen lds
    s_add_u32 m0, s5, 126976
    s_add_u32 s72, s71, 0
    buffer_load_dwordx4 v14, s[28:31], s72 offen lds
    v_mov_b32 v4, 161792
    s_waitcnt lgkmcnt(0)
    s_setprio 0
    s_cmp_lg_u32 s3, 0
    s_cbranch_scc1 L_nogate_15
    v_mfma_f32_32x32x16_bf16 v[100:115], v[32:35], a[112:115], v[100:115]
    v_mfma_f32_32x32x16_bf16 v[100:115], v[36:39], a[116:119], v[100:115]
    v_mfma_f32_32x32x16_bf16 v[100:115], v[40:43], a[120:123], v[100:115]
    v_mfma_f32_32x32x16_bf16 v[100:115], v[44:47], a[124:127], v[100:115]
    s_mov_b32 s73, 0xbfb8aa3b
    v_and_b32 v16, 31, v1
    v_lshlrev_b32 v16, 2, v16
    v_add_u32 v16, 161856, v16
    s_nop 7
    v_cvt_pk_bf16_f32 v17, v100, v100
    v_and_b32 v17, 0xffff0000, v17
    v_mul_f32 v17, s73, v17
    v_exp_f32 v17, v17
    s_nop 0
    v_add_f32 v17, 1.0, v17
    v_rcp_f32 v17, v17
    s_nop 0
    v_cvt_pk_bf16_f32 v17, v17, v17
    v_and_b32 v17, 0xffff0000, v17
    ds_write_b32 v16, v17
L_nogate_15:
    s_setprio 3
    s_waitcnt vmcnt(0) lgkmcnt(0)
    v_mov_b32 v5, 1
    s_mov_b64 exec, 1
    ds_add_u32 v4, v5 offset:0
    s_mov_b64 exec, -1
    s_mov_b32 s7, 0
L_spin_16:
    ds_read_b32 v5, v4 offset:0
    s_waitcnt lgkmcnt(0)
    v_readfirstlane_b32 s72, v5
    s_add_u32 s7, s7, 1
    s_cmp_ge_u32 s72, 4
    s_cbranch_scc1 L_spun_17
    s_sleep 1
    s_cmp_lt_u32 s7, 65536
    s_cbranch_scc1 L_spin_16
L_spun_17:
    v_lshrrev_b32 v6, 2, v1
    v_and_b32 v7, 3, v1
    v_lshlrev_b32 v6, 10, v6
    v_lshl_add_u32 v6, v7, 4, v6
    s_bfe_u32 s73, s2, 0x50002
    s_lshl_b32 s73, s73, 14
    s_and_b32 s74, s2, 3
    s_lshl_b32 s74, s74, 2
    s_add_u32 s74, s74, s62
    s_lshl_b32 s75, s74, 6
    s_add_u32 s73, s73, s75
    s_add_u32 m0, s5, 157696
    s_cmp_ge_u32 s2, 128
    s_cbranch_scc1 L_wob_18
    buffer_load_dwordx4 v6, s[36:39], s73 offen lds
    s_branch L_wogot_19
L_wob_18:
    buffer_load_dwordx4 v6, s[40:43], s73 offen lds
L_wogot_19:
    s_lshl_b32 s74, s74, 6
    s_lshr_b32 s73, s2, 2
    s_add_u32 s13, s74, s73
    v_add_u32 v15, 98304, v12
    ds_read_b64_tr_b16 v[16:17], v15 offset:0
    ds_read_b64_tr_b16 v[18:19], v15 offset:256
    ds_read_b64_tr_b16 v[20:21], v15 offset:1024
    ds_read_b64_tr_b16 v[22:23], v15 offset:1280
    ds_read_b64_tr_b16 v[24:25], v15 offset:2048
    ds_read_b64_tr_b16 v[26:27], v15 offset:2304
    ds_read_b64_tr_b16 v[28:29], v15 offset:3072
    ds_read_b64_tr_b16 v[30:31], v15 offset:3328
    s_waitcnt lgkmcnt(6)
    v_mfma_f32_32x32x16_bf16 v[64:79], v[16:19], a[0:3], 0
    ds_read_b64_tr_b16 v[16:17], v15 offset:4096
    ds_read_b64_tr_b16 v[18:19], v15 offset:4352
    s_waitcnt lgkmcnt(6)
    v_mfma_f32_32x32x16_bf16 v[64:79], v[20:23], a[4:7], v[64:79]
    ds_read_b64_tr_b16 v[20:21], v15 offset:5120
    ds_read_b64_tr_b16 v[22:23], v15 offset:5376
    s_waitcnt lgkmcnt(6)
    v_mfma_f32_32x32x16_bf16 v[64:79], v[24:27], a[8:11], v[64:79]
    ds_read_b64_tr_b16 v[24:25], v15 offset:6144
    ds_read_b64_tr_b16 v[26:27], v15 offset:6400
    s_waitcnt lgkmcnt(6)
    v_mfma_f32_32x32x16_bf16 v[64:79], v[28:31], a[12:15], v[64:79]
    ds_read_b64_tr_b16 v[28:29], v15 offset:7168
    ds_read_b64_tr_b16 v[30:31], v15 offset:7424
    s_waitcnt lgkmcnt(6)
    v_mfma_f32_32x32x16_bf16 v[64:79], v[16:19], a[16:19], v[64:79]
    ds_read_b64_tr_b16 v[16:17], v15 offset:8192
    ds_read_b64_tr_b16 v[18:19], v15 offset:8448
    s_waitcnt lgkmcnt(6)
    v_mfma_f32_32x32x16_bf16 v[64:79], v[20:23], a[20:23], v[64:79]
    ds_read_b64_tr_b16 v[20:21], v15 offset:9216
    ds_read_b64_tr_b16 v[22:23], v15 offset:9472
    s_waitcnt lgkmcnt(6)
    v_mfma_f32_32x32x16_bf16 v[64:79], v[24:27], a[24:27], v[64:79]
    ds_read_b64_tr_b16 v[24:25], v15 offset:10240
    ds_read_b64_tr_b16 v[26:27], v15 offset:10496
    s_waitcnt lgkmcnt(6)
    v_mfma_f32_32x32x16_bf16 v[64:79], v[28:31], a[28:31], v[64:79]
    ds_read_b64_tr_b16 v[28:29], v15 offset:11264
    ds_read_b64_tr_b16 v[30:31], v15 offset:11520
    s_waitcnt lgkmcnt(6)
    v_mfma_f32_32x32x16_bf16 v[64:79], v[16:19], a[32:35], v[64:79]
    ds_read_b64_tr_b16 v[16:17], v15 offset:12288
    ds_read_b64_tr_b16 v[18:19], v15 offset:12544
    s_waitcnt lgkmcnt(6)
    v_mfma_f32_32x32x16_bf16 v[64:79], v[20:23], a[36:39], v[64:79]
    ds_read_b64_tr_b16 v[20:21], v15 offset:13312
    ds_read_b64_tr_b16 v[22:23], v15 offset:13568
    s_waitcnt lgkmcnt(6)
    v_mfma_f32_32x32x16_bf16 v[64:79], v[24:27], a[40:43], v[64:79]
    ds_read_b64_tr_b16 v[24:25], v15 offset:14336
    ds_read_b64_tr_b16 v[26:27], v15 offset:14592
    s_waitcnt lgkmcnt(6)
    v_mfma_f32_32x32x16_bf16 v[64:79], v[28:31], a[44:47], v[64:79]
    ds_read_b64_tr_b16 v[28:29], v15 offset:15360
    ds_read_b64_tr_b16 v[30:31], v15 offset:15616
    s_waitcnt lgkmcnt(6)
    v_mfma_f32_32x32x16_bf16 v[64:79], v[16:19], a[48:51], v[64:79]
    ds_read_b64_tr_b16 v[16:17], v15 offset:16384
    ds_read_b64_tr_b16 v[18:19], v15 offset:16640
    s_waitcnt lgkmcnt(6)
    v_mfma_f32_32x32x16_bf16 v[64:79], v[20:23], a[52:55], v[64:79]
    ds_read_b64_tr_b16 v[20:21], v15 offset:17408
    ds_read_b64_tr_b16 v[22:23], v15 offset:17664
    s_waitcnt lgkmcnt(6)
    v_mfma_f32_32x32x16_bf16 v[64:79], v[24:27], a[56:59], v[64:79]
    ds_read_b64_tr_b16 v[24:25], v15 offset:18432
    ds_read_b64_tr_b16 v[26:27], v15 offset:18688
    s_waitcnt lgkmcnt(6)
    v_mfma_f32_32x32x16_bf16 v[64:79], v[28:31], a[60:63], v[64:79]
    ds_read_b64_tr_b16 v[28:29], v15 offset:19456
    ds_read_b64_tr_b16 v[30:31], v15 offset:19712
    s_waitcnt lgkmcnt(6)
    v_mfma_f32_32x32x16_bf16 v[64:79], v[16:19], a[64:67], v[64:79]
    ds_read_b64_tr_b16 v[16:17], v15 offset:20480
    ds_read_b64_tr_b16 v[18:19], v15 offset:20736
    s_waitcnt lgkmcnt(6)
    v_mfma_f32_32x32x16_bf16 v[64:79], v[20:23], a[68:71], v[64:79]
    ds_read_b64_tr_b16 v[20:21], v15 offset:21504
    ds_read_b64_tr_b16 v[22:23], v15 offset:21760
    s_waitcnt lgkmcnt(6)
    v_mfma_f32_32x32x16_bf16 v[64:79], v[24:27], a[72:75], v[64:79]
    ds_read_b64_tr_b16 v[24:25], v15 offset:22528
    ds_read_b64_tr_b16 v[26:27], v15 offset:22784
    s_waitcnt lgkmcnt(6)
    v_mfma_f32_32x32x16_bf16 v[64:79], v[28:31], a[76:79], v[64:79]
    ds_read_b64_tr_b16 v[28:29], v15 offset:23552
    ds_read_b64_tr_b16 v[30:31], v15 offset:23808
    s_waitcnt lgkmcnt(6)
    v_mfma_f32_32x32x16_bf16 v[64:79], v[16:19], a[80:83], v[64:79]
    ds_read_b64_tr_b16 v[16:17], v15 offset:24576
    ds_read_b64_tr_b16 v[18:19], v15 offset:24832
    s_waitcnt lgkmcnt(6)
    v_mfma_f32_32x32x16_bf16 v[64:79], v[20:23], a[84:87], v[64:79]
    ds_read_b64_tr_b16 v[20:21], v15 offset:25600
    ds_read_b64_tr_b16 v[22:23], v15 offset:25856
    s_waitcnt lgkmcnt(6)
    v_mfma_f32_32x32x16_bf16 v[64:79], v[24:27], a[88:91], v[64:79]
    ds_read_b64_tr_b16 v[24:25], v15 offset:26624
    ds_read_b64_tr_b16 v[26:27], v15 offset:26880
    s_waitcnt lgkmcnt(6)
    v_mfma_f32_32x32x16_bf16 v[64:79], v[28:31], a[92:95], v[64:79]
    ds_read_b64_tr_b16 v[28:29], v15 offset:27648
    ds_read_b64_tr_b16 v[30:31], v15 offset:27904
    s_waitcnt lgkmcnt(6)
    v_mfma_f32_32x32x16_bf16 v[64:79], v[16:19], a[96:99], v[64:79]
    ds_read_b64_tr_b16 v[16:17], v15 offset:28672
    ds_read_b64_tr_b16 v[18:19], v15 offset:28928
    s_waitcnt lgkmcnt(6)
    v_mfma_f32_32x32x16_bf16 v[64:79], v[20:23], a[100:103], v[64:79]
    ds_read_b64_tr_b16 v[20:21], v15 offset:29696
    ds_read_b64_tr_b16 v[22:23], v15 offset:29952
    s_waitcnt lgkmcnt(6)
    v_mfma_f32_32x32x16_bf16 v[64:79], v[24:27], a[104:107], v[64:79]
    ds_read_b64_tr_b16 v[24:25], v15 offset:30720
    ds_read_b64_tr_b16 v[26:27], v15 offset:30976
    s_waitcnt lgkmcnt(6)
    v_mfma_f32_32x32x16_bf16 v[64:79], v[28:31], a[108:111], v[64:79]
    ds_read_b64_tr_b16 v[28:29], v15 offset:31744
    ds_read_b64_tr_b16 v[30:31], v15 offset:32000
    s_waitcnt lgkmcnt(6)
    v_mfma_f32_32x32x16_bf16 v[64:79], v[16:19], a[112:115], v[64:79]
    s_waitcnt lgkmcnt(4)
    v_mfma_f32_32x32x16_bf16 v[64:79], v[20:23], a[116:119], v[64:79]
    s_waitcnt lgkmcnt(2)
    v_mfma_f32_32x32x16_bf16 v[64:79], v[24:27], a[120:123], v[64:79]
    s_waitcnt lgkmcnt(0)
    v_mfma_f32_32x32x16_bf16 v[64:79], v[28:31], a[124:127], v[64:79]
    s_mov_b32 s73, 0x3eb8aa3b
    s_lshl_b32 s74, s62, 11
    s_add_u32 s74, s74, 131072
    v_lshlrev_b32 v2, 4, v1
    v_add_u32 v2, s74, v2
    s_nop 7
    v_mul_f32 v64, s73, v64
    v_mul_f32 v65, s73, v65
    v_mul_f32 v66, s73, v66
    v_mul_f32 v67, s73, v67
    v_mul_f32 v68, s73, v68
    v_mul_f32 v69, s73, v69
    v_mul_f32 v70, s73, v70
    v_mul_f32 v71, s73, v71
    v_mul_f32 v72, s73, v72
    v_mul_f32 v73, s73, v73
    v_mul_f32 v74, s73, v74
    v_mul_f32 v75, s73, v75
    v_mul_f32 v76, s73, v76
    v_mul_f32 v77, s73, v77
    v_mul_f32 v78, s73, v78
    v_mul_f32 v79, s73, v79
    v_cvt_pk_bf16_f32 v16, v64, v65
    v_cvt_pk_bf16_f32 v17, v66, v67
    v_cvt_pk_bf16_f32 v18, v68, v69
    v_cvt_pk_bf16_f32 v19, v70, v71
    v_cvt_pk_bf16_f32 v20, v72, v73
    v_cvt_pk_bf16_f32 v21, v74, v75
    v_cvt_pk_bf16_f32 v22, v76, v77
    v_cvt_pk_bf16_f32 v23, v78, v79
    ds_write_b128 v2, v[16:19]
    ds_write_b128 v2, v[20:23] offset:1024
    s_waitcnt lgkmcnt(0)
    v_mov_b32 v5, 1
    s_mov_b64 exec, 1
    ds_add_u32 v4, v5 offset:20
    s_mov_b64 exec, -1
    s_setprio 0
    s_add_u32 m0, s5, 4096
    s_add_u32 s72, s64, 1024
    buffer_load_dwordx4 v14, s[32:35], s72 offen lds
    s_setprio 3
    s_setprio 0
    s_add_u32 m0, s5, 8192
    s_add_u32 s72, s64, 2048
    buffer_load_dwordx4 v14, s[32:35], s72 offen lds
    s_setprio 3
    s_setprio 0
    s_add_u32 m0, s5, 16384
    s_add_u32 s72, s65, 1024
    buffer_load_dwordx4 v14, s[32:35], s72 offen lds
    s_setprio 3
    s_setprio 0
    s_add_u32 m0, s5, 20480
    s_add_u32 s72, s65, 2048
    buffer_load_dwordx4 v14, s[32:35], s72 offen lds
    s_setprio 3
    s_setprio 0
    s_add_u32 m0, s5, 28672
    s_add_u32 s72, s66, 1024
    buffer_load_dwordx4 v14, s[32:35], s72 offen lds
    s_setprio 3
    s_setprio 0
    s_add_u32 m0, s5, 32768
    s_add_u32 s72, s66, 2048
    buffer_load_dwordx4 v14, s[32:35], s72 offen lds
    s_setprio 3
    s_setprio 0
    s_add_u32 m0, s5, 40960
    s_add_u32 s72, s67, 1024
    buffer_load_dwordx4 v14, s[32:35], s72 offen lds
    s_setprio 3
    s_setprio 0
    s_add_u32 m0, s5, 45056
    s_add_u32 s72, s67, 2048
    buffer_load_dwordx4 v14, s[32:35], s72 offen lds
    s_setprio 3
    s_waitcnt vmcnt(4)
    v_mov_b32 v5, 1
    s_mov_b64 exec, 1
    ds_add_u32 v4, v5 offset:0
    s_mov_b64 exec, -1
    s_mov_b32 s7, 0
L_spin_20:
    ds_read_b32 v5, v4 offset:0
    s_waitcnt lgkmcnt(0)
    v_readfirstlane_b32 s72, v5
    s_add_u32 s7, s7, 1
    s_cmp_ge_u32 s72, 8
    s_cbranch_scc1 L_spun_21
    s_sleep 1
    s_cmp_lt_u32 s7, 65536
    s_cbranch_scc1 L_spin_20
L_spun_21:
    s_setprio 0
    ds_read_b64_tr_b16 v[16:17], v12 offset:4096
    ds_read_b64_tr_b16 v[18:19], v12 offset:4352
    ds_read_b64_tr_b16 v[20:21], v12 offset:8192
    ds_read_b64_tr_b16 v[22:23], v12 offset:8448
    ds_read_b64_tr_b16 v[24:25], v12 offset:5120
    ds_read_b64_tr_b16 v[26:27], v12 offset:5376
    ds_read_b64_tr_b16 v[28:29], v12 offset:9216
    ds_read_b64_tr_b16 v[30:31], v12 offset:9472
    ds_read_b64_tr_b16 v[32:33], v12 offset:6144
    ds_read_b64_tr_b16 v[34:35], v12 offset:6400
    ds_read_b64_tr_b16 v[36:37], v12 offset:10240
    ds_read_b64_tr_b16 v[38:39], v12 offset:10496
    ds_read_b64_tr_b16 v[40:41], v12 offset:7168
    ds_read_b64_tr_b16 v[42:43], v12 offset:7424
    ds_read_b64_tr_b16 v[44:45], v12 offset:11264
    ds_read_b64_tr_b16 v[46:47], v12 offset:11520
    s_waitcnt lgkmcnt(12)
    v_mfma_f32_32x32x16_bf16 v[68:83], a[0:3], v[16:19], 0
    v_mfma_f32_32x32x16_bf16 v[84:99], a[0:3], v[20:23], 0
    s_add_u32 m0, s5, 53248
    s_add_u32 s72, s68, 1024
    buffer_load_dwordx4 v14, s[32:35], s72 offen lds
    ds_read_b64_tr_b16 v[16:17], v12 offset:16384
    ds_read_b64_tr_b16 v[18:19], v12 offset:16640
    ds_read_b64_tr_b16 v[20:21], v12 offset:20480
    ds_read_b64_tr_b16 v[22:23], v12 offset:20736
    s_waitcnt lgkmcnt(12)
    v_mfma_f32_32x32x16_bf16 v[68:83], a[4:7], v[24:27], v[68:83]
    v_mfma_f32_32x32x16_bf16 v[84:99], a[4:7], v[28:31], v[84:99]
    s_add_u32 m0, s5, 57344
    s_add_u32 s72, s68, 2048
    buffer_load_dwordx4 v14, s[32:35], s72 offen lds
    ds_read_b64_tr_b16 v[24:25], v12 offset:17408
    ds_read_b64_tr_b16 v[26:27], v12 offset:17664
    ds_read_b64_tr_b16 v[28:29], v12 offset:21504
    ds_read_b64_tr_b16 v[30:31], v12 offset:21760
    s_waitcnt lgkmcnt(12)
    v_mfma_f32_32x32x16_bf16 v[68:83], a[8:11], v[32:35], v[68:83]
    v_mfma_f32_32x32x16_bf16 v[84:99], a[8:11], v[36:39], v[84:99]
    s_add_u32 m0, s5, 65536
    s_add_u32 s72, s69, 1024
    buffer_load_dwordx4 v14, s[32:35], s72 offen lds
    ds_read_b64_tr_b16 v[32:33], v12 offset:18432
    ds_read_b64_tr_b16 v[34:35], v12 offset:18688
    ds_read_b64_tr_b16 v[36:37], v12 offset:22528
    ds_read_b64_tr_b16 v[38:39], v12 offset:22784
    s_waitcnt lgkmcnt(12)
    v_mfma_f32_32x32x16_bf16 v[68:83], a[12:15], v[40:43], v[68:83]
    v_mfma_f32_32x32x16_bf16 v[84:99], a[12:15], v[44:47], v[84:99]
    s_add_u32 m0, s5, 69632
    s_add_u32 s72, s69, 2048
    buffer_load_dwordx4 v14, s[32:35], s72 offen lds
    ds_read_b64_tr_b16 v[40:41], v12 offset:19456
    ds_read_b64_tr_b16 v[42:43], v12 offset:19712
    ds_read_b64_tr_b16 v[44:45], v12 offset:23552
    ds_read_b64_tr_b16 v[46:47], v12 offset:23808
    s_waitcnt lgkmcnt(12)
    v_mfma_f32_32x32x16_bf16 v[68:83], a[16:19], v[16:19], v[68:83]
    v_mfma_f32_32x32x16_bf16 v[84:99], a[16:19], v[20:23], v[84:99]
    s_waitcnt lgkmcnt(8)
    v_mfma_f32_32x32x16_bf16 v[68:83], a[20:23], v[24:27], v[68:83]
    v_mfma_f32_32x32x16_bf16 v[84:99], a[20:23], v[28:31], v[84:99]
    s_waitcnt lgkmcnt(4)
    v_mfma_f32_32x32x16_bf16 v[68:83], a[24:27], v[32:35], v[68:83]
    v_mfma_f32_32x32x16_bf16 v[84:99], a[24:27], v[36:39], v[84:99]
    s_waitcnt lgkmcnt(0)
    v_mfma_f32_32x32x16_bf16 v[68:83], a[28:31], v[40:43], v[68:83]
    v_mfma_f32_32x32x16_bf16 v[84:99], a[28:31], v[44:47], v[84:99]
    s_setprio 3
    s_mov_b32 s7, 0
L_spin_22:
    ds_read_b32 v5, v4 offset:20
    s_waitcnt lgkmcnt(0)
    v_readfirstlane_b32 s72, v5
    s_add_u32 s7, s7, 1
    s_cmp_ge_u32 s72, 8
    s_cbranch_scc1 L_spun_23
    s_sleep 1
    s_cmp_lt_u32 s7, 65536
    s_cbranch_scc1 L_spin_22
L_spun_23:
    s_waitcnt vmcnt(4)
    v_lshrrev_b32 v6, 5, v1
    v_lshlrev_b32 v6, 8, v6
    v_bfe_u32 v7, v1, 2, 2
    v_lshl_add_u32 v6, v7, 6, v6
    v_bfe_u32 v7, v1, 4, 1
    v_lshl_add_u32 v6, v7, 5, v6
    v_and_b32 v7, 3, v1
    v_lshl_add_u32 v6, v7, 3, v6
    s_add_u32 s73, s5, 157696
    v_add_u32 v6, s73, v6
    ds_read_b64_tr_b16 v[8:9], v6
    ds_read_b64_tr_b16 v[10:11], v6 offset:512
    s_lshl_b32 s73, s13, 10
    s_add_u32 s73, s73, 10485760
    v_lshlrev_b32 v6, 4, v1
    s_waitcnt lgkmcnt(0)
    buffer_store_dwordx4 v[8:11], v6, s[52:55], s73 offen sc1
    v_mov_b32 v5, 1
    s_mov_b64 exec, 1
    ds_add_u32 v4, v5 offset:0
    s_mov_b64 exec, -1
    s_mov_b32 s7, 0
L_spin_24:
    ds_read_b32 v5, v4 offset:0
    s_waitcnt lgkmcnt(0)
    v_readfirstlane_b32 s72, v5
    s_add_u32 s7, s7, 1
    s_cmp_ge_u32 s72, 12
    s_cbranch_scc1 L_spun_25
    s_sleep 1
    s_cmp_lt_u32 s7, 65536
    s_cbranch_scc1 L_spin_24
L_spun_25:
    s_setprio 0
    ds_read_b64_tr_b16 v[16:17], v12 offset:28672
    ds_read_b64_tr_b16 v[18:19], v12 offset:28928
    ds_read_b64_tr_b16 v[20:21], v12 offset:32768
    ds_read_b64_tr_b16 v[22:23], v12 offset:33024
    ds_read_b64_tr_b16 v[24:25], v12 offset:29696
    ds_read_b64_tr_b16 v[26:27], v12 offset:29952
    ds_read_b64_tr_b16 v[28:29], v12 offset:33792
    ds_read_b64_tr_b16 v[30:31], v12 offset:34048
    ds_read_b64_tr_b16 v[32:33], v12 offset:30720
    ds_read_b64_tr_b16 v[34:35], v12 offset:30976
    ds_read_b64_tr_b16 v[36:37], v12 offset:34816
    ds_read_b64_tr_b16 v[38:39], v12 offset:35072
    ds_read_b64_tr_b16 v[40:41], v12 offset:31744
    ds_read_b64_tr_b16 v[42:43], v12 offset:32000
    ds_read_b64_tr_b16 v[44:45], v12 offset:35840
    ds_read_b64_tr_b16 v[46:47], v12 offset:36096
    s_waitcnt lgkmcnt(12)
    v_mfma_f32_32x32x16_bf16 v[68:83], a[32:35], v[16:19], v[68:83]
    v_mfma_f32_32x32x16_bf16 v[84:99], a[32:35], v[20:23], v[84:99]
    s_add_u32 m0, s5, 77824
    s_add_u32 s72, s70, 1024
    buffer_load_dwordx4 v14, s[32:35], s72 offen lds
    ds_read_b64_tr_b16 v[16:17], v12 offset:40960
    ds_read_b64_tr_b16 v[18:19], v12 offset:41216
    ds_read_b64_tr_b16 v[20:21], v12 offset:45056
    ds_read_b64_tr_b16 v[22:23], v12 offset:45312
    s_waitcnt lgkmcnt(12)
    v_mfma_f32_32x32x16_bf16 v[68:83], a[36:39], v[24:27], v[68:83]
    v_mfma_f32_32x32x16_bf16 v[84:99], a[36:39], v[28:31], v[84:99]
    s_add_u32 m0, s5, 81920
    s_add_u32 s72, s70, 2048
    buffer_load_dwordx4 v14, s[32:35], s72 offen lds
    ds_read_b64_tr_b16 v[24:25], v12 offset:41984
    ds_read_b64_tr_b16 v[26:27], v12 offset:42240
    ds_read_b64_tr_b16 v[28:29], v12 offset:46080
    ds_read_b64_tr_b16 v[30:31], v12 offset:46336
    s_waitcnt lgkmcnt(12)
    v_mfma_f32_32x32x16_bf16 v[68:83], a[40:43], v[32:35], v[68:83]
    v_mfma_f32_32x32x16_bf16 v[84:99], a[40:43], v[36:39], v[84:99]
    s_add_u32 m0, s5, 90112
    s_add_u32 s72, s71, 1024
    buffer_load_dwordx4 v14, s[32:35], s72 offen lds
    ds_read_b64_tr_b16 v[32:33], v12 offset:43008
    ds_read_b64_tr_b16 v[34:35], v12 offset:43264
    ds_read_b64_tr_b16 v[36:37], v12 offset:47104
    ds_read_b64_tr_b16 v[38:39], v12 offset:47360
    s_waitcnt lgkmcnt(12)
    v_mfma_f32_32x32x16_bf16 v[68:83], a[44:47], v[40:43], v[68:83]
    v_mfma_f32_32x32x16_bf16 v[84:99], a[44:47], v[44:47], v[84:99]
    s_add_u32 m0, s5, 94208
    s_add_u32 s72, s71, 2048
    buffer_load_dwordx4 v14, s[32:35], s72 offen lds
    ds_read_b64_tr_b16 v[40:41], v12 offset:44032
    ds_read_b64_tr_b16 v[42:43], v12 offset:44288
    ds_read_b64_tr_b16 v[44:45], v12 offset:48128
    ds_read_b64_tr_b16 v[46:47], v12 offset:48384
    s_waitcnt lgkmcnt(12)
    v_mfma_f32_32x32x16_bf16 v[68:83], a[48:51], v[16:19], v[68:83]
    v_mfma_f32_32x32x16_bf16 v[84:99], a[48:51], v[20:23], v[84:99]
    s_add_u32 m0, s5, 0
    s_add_u32 s72, s64, 0
    buffer_load_dwordx4 v14, s[32:35], s72 offen lds
    s_waitcnt lgkmcnt(8)
    v_mfma_f32_32x32x16_bf16 v[68:83], a[52:55], v[24:27], v[68:83]
    v_mfma_f32_32x32x16_bf16 v[84:99], a[52:55], v[28:31], v[84:99]
    s_add_u32 m0, s5, 12288
    s_add_u32 s72, s65, 0
    buffer_load_dwordx4 v14, s[32:35], s72 offen lds
    s_waitcnt lgkmcnt(4)
    v_mfma_f32_32x32x16_bf16 v[68:83], a[56:59], v[32:35], v[68:83]
    v_mfma_f32_32x32x16_bf16 v[84:99], a[56:59], v[36:39], v[84:99]
    s_add_u32 m0, s5, 24576
    s_add_u32 s72, s66, 0
    buffer_load_dwordx4 v14, s[32:35], s72 offen lds
    s_waitcnt lgkmcnt(0)
    v_mfma_f32_32x32x16_bf16 v[68:83], a[60:63], v[40:43], v[68:83]
    v_mfma_f32_32x32x16_bf16 v[84:99], a[60:63], v[44:47], v[84:99]
    s_add_u32 m0, s5, 36864
    s_add_u32 s72, s67, 0
    buffer_load_dwordx4 v14, s[32:35], s72 offen lds
    s_setprio 3
    s_waitcnt vmcnt(9)
    v_mov_b32 v5, 1
    s_mov_b64 exec, 1
    ds_add_u32 v4, v5 offset:0
    s_mov_b64 exec, -1
    s_mov_b32 s7, 0
L_spin_26:
    ds_read_b32 v5, v4 offset:0
    s_waitcnt lgkmcnt(0)
    v_readfirstlane_b32 s72, v5
    s_add_u32 s7, s7, 1
    s_cmp_ge_u32 s72, 16
    s_cbranch_scc1 L_spun_27
    s_sleep 1
    s_cmp_lt_u32 s7, 65536
    s_cbranch_scc1 L_spin_26
L_spun_27:
    s_setprio 0
    ds_read_b64_tr_b16 v[16:17], v13 offset:4096
    ds_read_b64_tr_b16 v[18:19], v13 offset:4352
    ds_read_b64_tr_b16 v[20:21], v13 offset:8192
    ds_read_b64_tr_b16 v[22:23], v13 offset:8448
    ds_read_b64_tr_b16 v[24:25], v13 offset:5120
    ds_read_b64_tr_b16 v[26:27], v13 offset:5376
    ds_read_b64_tr_b16 v[28:29], v13 offset:9216
    ds_read_b64_tr_b16 v[30:31], v13 offset:9472
    ds_read_b64_tr_b16 v[32:33], v13 offset:6144
    ds_read_b64_tr_b16 v[34:35], v13 offset:6400
    ds_read_b64_tr_b16 v[36:37], v13 offset:10240
    ds_read_b64_tr_b16 v[38:39], v13 offset:10496
    ds_read_b64_tr_b16 v[40:41], v13 offset:7168
    ds_read_b64_tr_b16 v[42:43], v13 offset:7424
    ds_read_b64_tr_b16 v[44:45], v13 offset:11264
    ds_read_b64_tr_b16 v[46:47], v13 offset:11520
    s_waitcnt lgkmcnt(12)
    v_mfma_f32_32x32x16_bf16 v[68:83], a[64:67], v[16:19], v[68:83]
    v_mfma_f32_32x32x16_bf16 v[84:99], a[64:67], v[20:23], v[84:99]
    s_add_u32 m0, s5, 49152
    s_add_u32 s72, s68, 0
    buffer_load_dwordx4 v14, s[32:35], s72 offen lds
    ds_read_b64_tr_b16 v[16:17], v13 offset:16384
    ds_read_b64_tr_b16 v[18:19], v13 offset:16640
    ds_read_b64_tr_b16 v[20:21], v13 offset:20480
    ds_read_b64_tr_b16 v[22:23], v13 offset:20736
    s_waitcnt lgkmcnt(12)
    v_mfma_f32_32x32x16_bf16 v[68:83], a[68:71], v[24:27], v[68:83]
    v_mfma_f32_32x32x16_bf16 v[84:99], a[68:71], v[28:31], v[84:99]
    s_add_u32 m0, s5, 61440
    s_add_u32 s72, s69, 0
    buffer_load_dwordx4 v14, s[32:35], s72 offen lds
    ds_read_b64_tr_b16 v[24:25], v13 offset:17408
    ds_read_b64_tr_b16 v[26:27], v13 offset:17664
    ds_read_b64_tr_b16 v[28:29], v13 offset:21504
    ds_read_b64_tr_b16 v[30:31], v13 offset:21760
    s_waitcnt lgkmcnt(12)
    v_mfma_f32_32x32x16_bf16 v[68:83], a[72:75], v[32:35], v[68:83]
    v_mfma_f32_32x32x16_bf16 v[84:99], a[72:75], v[36:39], v[84:99]
    s_add_u32 m0, s5, 73728
    s_add_u32 s72, s70, 0
    buffer_load_dwordx4 v14, s[32:35], s72 offen lds
    ds_read_b64_tr_b16 v[32:33], v13 offset:18432
    ds_read_b64_tr_b16 v[34:35], v13 offset:18688
    ds_read_b64_tr_b16 v[36:37], v13 offset:22528
    ds_read_b64_tr_b16 v[38:39], v13 offset:22784
    s_waitcnt lgkmcnt(12)
    v_mfma_f32_32x32x16_bf16 v[68:83], a[76:79], v[40:43], v[68:83]
    v_mfma_f32_32x32x16_bf16 v[84:99], a[76:79], v[44:47], v[84:99]
    s_add_u32 m0, s5, 86016
    s_add_u32 s72, s71, 0
    buffer_load_dwordx4 v14, s[32:35], s72 offen lds
    ds_read_b64_tr_b16 v[40:41], v13 offset:19456
    ds_read_b64_tr_b16 v[42:43], v13 offset:19712
    ds_read_b64_tr_b16 v[44:45], v13 offset:23552
    ds_read_b64_tr_b16 v[46:47], v13 offset:23808
    s_waitcnt lgkmcnt(12)
    v_mfma_f32_32x32x16_bf16 v[68:83], a[80:83], v[16:19], v[68:83]
    v_mfma_f32_32x32x16_bf16 v[84:99], a[80:83], v[20:23], v[84:99]
    s_waitcnt lgkmcnt(8)
    v_mfma_f32_32x32x16_bf16 v[68:83], a[84:87], v[24:27], v[68:83]
    v_mfma_f32_32x32x16_bf16 v[84:99], a[84:87], v[28:31], v[84:99]
    s_waitcnt lgkmcnt(4)
    v_mfma_f32_32x32x16_bf16 v[68:83], a[88:91], v[32:35], v[68:83]
    v_mfma_f32_32x32x16_bf16 v[84:99], a[88:91], v[36:39], v[84:99]
    s_waitcnt lgkmcnt(0)
    v_mfma_f32_32x32x16_bf16 v[68:83], a[92:95], v[40:43], v[68:83]
    v_mfma_f32_32x32x16_bf16 v[84:99], a[92:95], v[44:47], v[84:99]
    s_setprio 3
    s_waitcnt vmcnt(8)
    v_mov_b32 v5, 1
    s_mov_b64 exec, 1
    ds_add_u32 v4, v5 offset:0
    s_mov_b64 exec, -1
    s_mov_b32 s7, 0
L_spin_28:
    ds_read_b32 v5, v4 offset:0
    s_waitcnt lgkmcnt(0)
    v_readfirstlane_b32 s72, v5
    s_add_u32 s7, s7, 1
    s_cmp_ge_u32 s72, 20
    s_cbranch_scc1 L_spun_29
    s_sleep 1
    s_cmp_lt_u32 s7, 65536
    s_cbranch_scc1 L_spin_28
L_spun_29:
    s_setprio 0
    ds_read_b64_tr_b16 v[16:17], v13 offset:28672
    ds_read_b64_tr_b16 v[18:19], v13 offset:28928
    ds_read_b64_tr_b16 v[20:21], v13 offset:32768
    ds_read_b64_tr_b16 v[22:23], v13 offset:33024
    ds_read_b64_tr_b16 v[24:25], v13 offset:29696
    ds_read_b64_tr_b16 v[26:27], v13 offset:29952
    ds_read_b64_tr_b16 v[28:29], v13 offset:33792
    ds_read_b64_tr_b16 v[30:31], v13 offset:34048
    ds_read_b64_tr_b16 v[32:33], v13 offset:30720
    ds_read_b64_tr_b16 v[34:35], v13 offset:30976
    ds_read_b64_tr_b16 v[36:37], v13 offset:34816
    ds_read_b64_tr_b16 v[38:39], v13 offset:35072
    ds_read_b64_tr_b16 v[40:41], v13 offset:31744
    ds_read_b64_tr_b16 v[42:43], v13 offset:32000
    ds_read_b64_tr_b16 v[44:45], v13 offset:35840
    ds_read_b64_tr_b16 v[46:47], v13 offset:36096
    s_waitcnt lgkmcnt(12)
    v_mfma_f32_32x32x16_bf16 v[68:83], a[96:99], v[16:19], v[68:83]
    v_mfma_f32_32x32x16_bf16 v[84:99], a[96:99], v[20:23], v[84:99]
    ds_read_b64_tr_b16 v[16:17], v13 offset:40960
    ds_read_b64_tr_b16 v[18:19], v13 offset:41216
    ds_read_b64_tr_b16 v[20:21], v13 offset:45056
    ds_read_b64_tr_b16 v[22:23], v13 offset:45312
    s_waitcnt lgkmcnt(12)
    v_mfma_f32_32x32x16_bf16 v[68:83], a[100:103], v[24:27], v[68:83]
    v_mfma_f32_32x32x16_bf16 v[84:99], a[100:103], v[28:31], v[84:99]
    ds_read_b64_tr_b16 v[24:25], v13 offset:41984
    ds_read_b64_tr_b16 v[26:27], v13 offset:42240
    ds_read_b64_tr_b16 v[28:29], v13 offset:46080
    ds_read_b64_tr_b16 v[30:31], v13 offset:46336
    s_waitcnt lgkmcnt(12)
    v_mfma_f32_32x32x16_bf16 v[68:83], a[104:107], v[32:35], v[68:83]
    v_mfma_f32_32x32x16_bf16 v[84:99], a[104:107], v[36:39], v[84:99]
    ds_read_b64_tr_b16 v[32:33], v13 offset:43008
    ds_read_b64_tr_b16 v[34:35], v13 offset:43264
    ds_read_b64_tr_b16 v[36:37], v13 offset:47104
    ds_read_b64_tr_b16 v[38:39], v13 offset:47360
    s_waitcnt lgkmcnt(12)
    v_mfma_f32_32x32x16_bf16 v[68:83], a[108:111], v[40:43], v[68:83]
    v_mfma_f32_32x32x16_bf16 v[84:99], a[108:111], v[44:47], v[84:99]
    ds_read_b64_tr_b16 v[40:41], v13 offset:44032
    ds_read_b64_tr_b16 v[42:43], v13 offset:44288
    ds_read_b64_tr_b16 v[44:45], v13 offset:48128
    ds_read_b64_tr_b16 v[46:47], v13 offset:48384
    s_waitcnt lgkmcnt(12)
    v_mfma_f32_32x32x16_bf16 v[68:83], a[112:115], v[16:19], v[68:83]
    v_mfma_f32_32x32x16_bf16 v[84:99], a[112:115], v[20:23], v[84:99]
    s_waitcnt lgkmcnt(8)
    v_mfma_f32_32x32x16_bf16 v[68:83], a[116:119], v[24:27], v[68:83]
    v_mfma_f32_32x32x16_bf16 v[84:99], a[116:119], v[28:31], v[84:99]
    s_waitcnt lgkmcnt(4)
    v_mfma_f32_32x32x16_bf16 v[68:83], a[120:123], v[32:35], v[68:83]
    v_mfma_f32_32x32x16_bf16 v[84:99], a[120:123], v[36:39], v[84:99]
    s_waitcnt lgkmcnt(0)
    v_mfma_f32_32x32x16_bf16 v[68:83], a[124:127], v[40:43], v[68:83]
    v_mfma_f32_32x32x16_bf16 v[84:99], a[124:127], v[44:47], v[84:99]
    s_setprio 3
    s_lshl_b32 s73, s13, 3
    s_add_u32 s73, s73, 49152
    v_mov_b32 v3, 0
    s_waitcnt vmcnt(0)
    v_mov_b32 v6, s56
    v_mov_b32 v7, s57
    s_mov_b64 exec, 0x1
    buffer_store_dwordx2 v[6:7], v3, s[52:55], s73 offen sc1
    s_mov_b64 exec, -1
    v_mov_b32 v5, 1
    s_mov_b64 exec, 1
    ds_add_u32 v4, v5 offset:0
    s_mov_b64 exec, -1
    s_mov_b32 s8, 0x3fb8aa3b
    s_mov_b32 s9, 0x3fb8aa3b
    s_mov_b32 s76, 0x358637bd
    s_mov_b32 s10, 0x3f803f80
    v_pk_mul_f32 v[16:17], v[68:69], s[8:9]
    v_pk_mul_f32 v[18:19], v[70:71], s[8:9]
    v_pk_mul_f32 v[20:21], v[72:73], s[8:9]
    v_pk_mul_f32 v[22:23], v[74:75], s[8:9]
    v_pk_mul_f32 v[24:25], v[76:77], s[8:9]
    v_pk_mul_f32 v[26:27], v[78:79], s[8:9]
    v_pk_mul_f32 v[28:29], v[80:81], s[8:9]
    v_pk_mul_f32 v[30:31], v[82:83], s[8:9]
    v_exp_f32 v16, v16 clamp
    v_max_f32 v68, s76, v68
    v_exp_f32 v17, v17 clamp
    v_max_f32 v69, s76, v69
    v_exp_f32 v18, v18 clamp
    v_max_f32 v70, s76, v70
    v_exp_f32 v19, v19 clamp
    v_max_f32 v71, s76, v71
    v_exp_f32 v20, v20 clamp
    v_max_f32 v72, s76, v72
    v_exp_f32 v21, v21 clamp
    v_max_f32 v73, s76, v73
    v_exp_f32 v22, v22 clamp
    v_max_f32 v74, s76, v74
    v_exp_f32 v23, v23 clamp
    v_max_f32 v75, s76, v75
    v_exp_f32 v24, v24 clamp
    v_max_f32 v76, s76, v76
    v_exp_f32 v25, v25 clamp
    v_max_f32 v77, s76, v77
    v_exp_f32 v26, v26 clamp
    v_max_f32 v78, s76, v78
    v_exp_f32 v27, v27 clamp
    v_max_f32 v79, s76, v79
    v_exp_f32 v28, v28 clamp
    v_max_f32 v80, s76, v80
    v_exp_f32 v29, v29 clamp
    v_max_f32 v81, s76, v81
    v_exp_f32 v30, v30 clamp
    v_max_f32 v82, s76, v82
    v_exp_f32 v31, v31 clamp
    v_max_f32 v83, s76, v83
    v_pk_add_f32 v[68:69], v[68:69], v[16:17]
    v_pk_add_f32 v[70:71], v[70:71], v[18:19]
    v_pk_add_f32 v[72:73], v[72:73], v[20:21]
    v_pk_add_f32 v[74:75], v[74:75], v[22:23]
    v_pk_add_f32 v[76:77], v[76:77], v[24:25]
    v_pk_add_f32 v[78:79], v[78:79], v[26:27]
    v_pk_add_f32 v[80:81], v[80:81], v[28:29]
    v_pk_add_f32 v[82:83], v[82:83], v[30:31]
    v_cvt_pk_bf16_f32 v24, v68, v69
    v_cvt_pk_bf16_f32 v25, v70, v71
    v_cvt_pk_bf16_f32 v26, v72, v73
    v_cvt_pk_bf16_f32 v27, v74, v75
    v_cvt_pk_bf16_f32 v28, v76, v77
    v_cvt_pk_bf16_f32 v29, v78, v79
    v_cvt_pk_bf16_f32 v30, v80, v81
    v_cvt_pk_bf16_f32 v31, v82, v83
    v_cvt_pk_bf16_f32 v32, v84, v85
    v_cvt_pk_bf16_f32 v33, v86, v87
    v_cvt_pk_bf16_f32 v34, v88, v89
    v_cvt_pk_bf16_f32 v35, v90, v91
    v_cvt_pk_bf16_f32 v36, v92, v93
    v_cvt_pk_bf16_f32 v37, v94, v95
    v_cvt_pk_bf16_f32 v38, v96, v97
    v_cvt_pk_bf16_f32 v39, v98, v99
    v_mov_b32 v5, s10
    v_lshlrev_b32 v2, 4, v1
    v_cndmask_b32 v40, v32, v5, s[80:81]
    v_cndmask_b32 v41, v33, v5, s[80:81]
    v_cndmask_b32 v42, v34, v5, s[80:81]
    v_cndmask_b32 v43, v35, v5, s[80:81]
    v_cndmask_b32 v44, v36, v5, s[80:81]
    v_cndmask_b32 v45, v37, v5, s[80:81]
    v_cndmask_b32 v46, v38, v5, s[80:81]
    v_cndmask_b32 v47, v39, v5, s[80:81]
    v_cndmask_b32 v32, v5, v32, s[80:81]
    v_cndmask_b32 v33, v5, v33, s[80:81]
    v_cndmask_b32 v34, v5, v34, s[80:81]
    v_cndmask_b32 v35, v5, v35, s[80:81]
    v_cndmask_b32 v36, v5, v36, s[80:81]
    v_cndmask_b32 v37, v5, v37, s[80:81]
    v_cndmask_b32 v38, v5, v38, s[80:81]
    v_cndmask_b32 v39, v5, v39, s[80:81]
    s_nop 1
    v_mfma_f32_32x32x16_bf16 v[68:83], v[24:27], v[40:43], 0
    v_mfma_f32_32x32x16_bf16 v[52:67], v[24:27], v[32:35], 0
    v_mfma_f32_32x32x16_bf16 v[68:83], v[28:31], v[44:47], v[68:83]
    v_mfma_f32_32x32x16_bf16 v[52:67], v[28:31], v[36:39], v[52:67]
    s_lshl_b32 s73, s62, 12
    s_add_u32 s73, s73, 106496
    v_add_u32 v3, s73, v2
    s_nop 9
    ds_write_b128 v3, v[52:55]
    ds_write_b128 v3, v[56:59] offset:1024
    ds_write_b128 v3, v[76:79] offset:2048
    ds_write_b128 v3, v[80:83] offset:3072
    v_mov_b32 v5, 1
    s_waitcnt lgkmcnt(0)
    s_mov_b64 exec, 1
    ds_add_rtn_u32 v5, v4, v5 offset:4
    s_waitcnt lgkmcnt(0)
    v_readfirstlane_b32 s73, v5
    s_mov_b64 exec, -1
    s_mov_b32 s11, 0
    s_cmp_lg_u32 s73, 3
    s_cbranch_scc1 L_notlast_30
    v_add_u32 v3, 106496, v2
    ds_read_b128 v[16:19], v3 offset:0
    ds_read_b128 v[20:23], v3 offset:1024
    ds_read_b128 v[24:27], v3 offset:2048
    ds_read_b128 v[28:31], v3 offset:3072
    ds_read_b128 v[32:35], v3 offset:4096
    ds_read_b128 v[36:39], v3 offset:5120
    ds_read_b128 v[40:43], v3 offset:6144
    ds_read_b128 v[44:47], v3 offset:7168
    ds_read_b128 v[48:51], v3 offset:8192
    ds_read_b128 v[52:55], v3 offset:9216
    ds_read_b128 v[56:59], v3 offset:10240
    ds_read_b128 v[60:63], v3 offset:11264
    s_waitcnt lgkmcnt(4)
    v_pk_add_f32 v[16:17], v[16:17], v[32:33]
    v_pk_add_f32 v[18:19], v[18:19], v[34:35]
    v_pk_add_f32 v[20:21], v[20:21], v[36:37]
    v_pk_add_f32 v[22:23], v[22:23], v[38:39]
    v_pk_add_f32 v[24:25], v[24:25], v[40:41]
    v_pk_add_f32 v[26:27], v[26:27], v[42:43]
    v_pk_add_f32 v[28:29], v[28:29], v[44:45]
    v_pk_add_f32 v[30:31], v[30:31], v[46:47]
    ds_read_b128 v[64:67], v3 offset:12288
    ds_read_b128 v[68:71], v3 offset:13312
    ds_read_b128 v[72:75], v3 offset:14336
    ds_read_b128 v[76:79], v3 offset:15360
    s_waitcnt lgkmcnt(0)
    v_pk_add_f32 v[48:49], v[48:49], v[64:65]
    v_pk_add_f32 v[50:51], v[50:51], v[66:67]
    v_pk_add_f32 v[52:53], v[52:53], v[68:69]
    v_pk_add_f32 v[54:55], v[54:55], v[70:71]
    v_pk_add_f32 v[56:57], v[56:57], v[72:73]
    v_pk_add_f32 v[58:59], v[58:59], v[74:75]
    v_pk_add_f32 v[60:61], v[60:61], v[76:77]
    v_pk_add_f32 v[62:63], v[62:63], v[78:79]
    v_pk_add_f32 v[16:17], v[16:17], v[48:49]
    v_pk_add_f32 v[18:19], v[18:19], v[50:51]
    v_pk_add_f32 v[20:21], v[20:21], v[52:53]
    v_pk_add_f32 v[22:23], v[22:23], v[54:55]
    v_pk_add_f32 v[24:25], v[24:25], v[56:57]
    v_pk_add_f32 v[26:27], v[26:27], v[58:59]
    v_pk_add_f32 v[28:29], v[28:29], v[60:61]
    v_pk_add_f32 v[30:31], v[30:31], v[62:63]
    v_cvt_pk_bf16_f32 v88, v16, v17
    v_cvt_pk_bf16_f32 v89, v18, v19
    v_cvt_pk_bf16_f32 v90, v20, v21
    v_cvt_pk_bf16_f32 v91, v22, v23
    v_cvt_pk_bf16_f32 v92, v24, v25
    v_cvt_pk_bf16_f32 v93, v26, v27
    v_cvt_pk_bf16_f32 v94, v28, v29
    v_cvt_pk_bf16_f32 v95, v30, v31
    s_lshl_b32 s73, s58, 15
    s_lshl_b32 s74, s59, 10
    s_add_u32 s74, s74, s73
    s_add_u32 s74, s74, 5242880
    s_add_u32 s75, s74, 16384
    s_lshl_b32 s73, s58, 4
    s_add_u32 s73, s73, s59
    s_lshl_b32 s73, s73, 3
    s_add_u32 s11, s73, 12288
    buffer_store_dwordx4 v[88:91], v2, s[52:55], s74 offen sc1
    buffer_store_dwordx4 v[92:95], v2, s[52:55], s75 offen sc1
L_notlast_30:
    s_mov_b32 s7, 0
L_spin_31:
    ds_read_b32 v5, v4 offset:0
    s_waitcnt lgkmcnt(0)
    v_readfirstlane_b32 s72, v5
    s_add_u32 s7, s7, 1
    s_cmp_ge_u32 s72, 24
    s_cbranch_scc1 L_spun_32
    s_sleep 1
    s_cmp_lt_u32 s7, 65536
    s_cbranch_scc1 L_spin_31
L_spun_32:
    s_setprio 0
    ds_read_b64_tr_b16 v[16:17], v12 offset:0
    ds_read_b64_tr_b16 v[18:19], v12 offset:256
    ds_read_b64_tr_b16 v[20:21], v12 offset:1024
    ds_read_b64_tr_b16 v[22:23], v12 offset:1280
    ds_read_b64_tr_b16 v[24:25], v12 offset:2048
    ds_read_b64_tr_b16 v[26:27], v12 offset:2304
    ds_read_b64_tr_b16 v[28:29], v12 offset:3072
    ds_read_b64_tr_b16 v[30:31], v12 offset:3328
    ds_read_b64_tr_b16 v[32:33], v12 offset:12288
    ds_read_b64_tr_b16 v[34:35], v12 offset:12544
    ds_read_b64_tr_b16 v[36:37], v12 offset:13312
    ds_read_b64_tr_b16 v[38:39], v12 offset:13568
    s_waitcnt lgkmcnt(10)
    v_mfma_f32_32x32x16_bf16 v[52:67], v[16:19], a[0:3], 0
    ds_read_b64_tr_b16 v[16:17], v12 offset:14336
    ds_read_b64_tr_b16 v[18:19], v12 offset:14592
    s_waitcnt lgkmcnt(10)
    v_mfma_f32_32x32x16_bf16 v[52:67], v[20:23], a[4:7], v[52:67]
    ds_read_b64_tr_b16 v[20:21], v12 offset:15360
    ds_read_b64_tr_b16 v[22:23], v12 offset:15616
    s_waitcnt lgkmcnt(10)
    v_mfma_f32_32x32x16_bf16 v[52:67], v[24:27], a[8:11], v[52:67]
    ds_read_b64_tr_b16 v[24:25], v12 offset:24576
    ds_read_b64_tr_b16 v[26:27], v12 offset:24832
    s_waitcnt lgkmcnt(10)
    v_mfma_f32_32x32x16_bf16 v[52:67], v[28:31], a[12:15], v[52:67]
    ds_read_b64_tr_b16 v[28:29], v12 offset:25600
    ds_read_b64_tr_b16 v[30:31], v12 offset:25856
    s_waitcnt lgkmcnt(10)
    v_mfma_f32_32x32x16_bf16 v[52:67], v[32:35], a[16:19], v[52:67]
    ds_read_b64_tr_b16 v[32:33], v12 offset:26624
    ds_read_b64_tr_b16 v[34:35], v12 offset:26880
    s_waitcnt lgkmcnt(10)
    v_mfma_f32_32x32x16_bf16 v[52:67], v[36:39], a[20:23], v[52:67]
    ds_read_b64_tr_b16 v[36:37], v12 offset:27648
    ds_read_b64_tr_b16 v[38:39], v12 offset:27904
    s_waitcnt lgkmcnt(10)
    v_mfma_f32_32x32x16_bf16 v[52:67], v[16:19], a[24:27], v[52:67]
    ds_read_b64_tr_b16 v[16:17], v12 offset:36864
    ds_read_b64_tr_b16 v[18:19], v12 offset:37120
    s_waitcnt lgkmcnt(10)
    v_mfma_f32_32x32x16_bf16 v[52:67], v[20:23], a[28:31], v[52:67]
    ds_read_b64_tr_b16 v[20:21], v12 offset:37888
    ds_read_b64_tr_b16 v[22:23], v12 offset:38144
    s_waitcnt lgkmcnt(10)
    v_mfma_f32_32x32x16_bf16 v[52:67], v[24:27], a[32:35], v[52:67]
    ds_read_b64_tr_b16 v[24:25], v12 offset:38912
    ds_read_b64_tr_b16 v[26:27], v12 offset:39168
    s_waitcnt lgkmcnt(10)
    v_mfma_f32_32x32x16_bf16 v[52:67], v[28:31], a[36:39], v[52:67]
    ds_read_b64_tr_b16 v[28:29], v12 offset:39936
    ds_read_b64_tr_b16 v[30:31], v12 offset:40192
    s_waitcnt lgkmcnt(10)
    v_mfma_f32_32x32x16_bf16 v[52:67], v[32:35], a[40:43], v[52:67]
    ds_read_b64_tr_b16 v[32:33], v13 offset:0
    ds_read_b64_tr_b16 v[34:35], v13 offset:256
    s_waitcnt lgkmcnt(10)
    v_mfma_f32_32x32x16_bf16 v[52:67], v[36:39], a[44:47], v[52:67]
    ds_read_b64_tr_b16 v[36:37], v13 offset:1024
    ds_read_b64_tr_b16 v[38:39], v13 offset:1280
    s_waitcnt lgkmcnt(10)
    v_mfma_f32_32x32x16_bf16 v[52:67], v[16:19], a[48:51], v[52:67]
    ds_read_b64_tr_b16 v[16:17], v13 offset:2048
    ds_read_b64_tr_b16 v[18:19], v13 offset:2304
    s_waitcnt lgkmcnt(10)
    v_mfma_f32_32x32x16_bf16 v[52:67], v[20:23], a[52:55], v[52:67]
    ds_read_b64_tr_b16 v[20:21], v13 offset:3072
    ds_read_b64_tr_b16 v[22:23], v13 offset:3328
    s_waitcnt lgkmcnt(10)
    v_mfma_f32_32x32x16_bf16 v[52:67], v[24:27], a[56:59], v[52:67]
    s_cmp_eq_u32 s11, 0
    s_cbranch_scc1 L_noz_33
    s_setprio 3
    v_mov_b32 v3, 0
    s_waitcnt vmcnt(0)
    v_mov_b32 v6, s56
    v_mov_b32 v7, s57
    s_mov_b64 exec, 0x1
    buffer_store_dwordx2 v[6:7], v3, s[52:55], s11 offen sc1
    s_mov_b64 exec, -1
    s_setprio 0
L_noz_33:
    ds_read_b64_tr_b16 v[24:25], v13 offset:12288
    ds_read_b64_tr_b16 v[26:27], v13 offset:12544
    s_waitcnt lgkmcnt(10)
    v_mfma_f32_32x32x16_bf16 v[52:67], v[28:31], a[60:63], v[52:67]
    ds_read_b64_tr_b16 v[28:29], v13 offset:13312
    ds_read_b64_tr_b16 v[30:31], v13 offset:13568
    s_waitcnt lgkmcnt(10)
    v_mfma_f32_32x32x16_bf16 v[52:67], v[32:35], a[64:67], v[52:67]
    ds_read_b64_tr_b16 v[32:33], v13 offset:14336
    ds_read_b64_tr_b16 v[34:35], v13 offset:14592
    s_waitcnt lgkmcnt(10)
    v_mfma_f32_32x32x16_bf16 v[52:67], v[36:39], a[68:71], v[52:67]
    ds_read_b64_tr_b16 v[36:37], v13 offset:15360
    ds_read_b64_tr_b16 v[38:39], v13 offset:15616
    s_waitcnt lgkmcnt(10)
    v_mfma_f32_32x32x16_bf16 v[52:67], v[16:19], a[72:75], v[52:67]
    ds_read_b64_tr_b16 v[16:17], v13 offset:24576
    ds_read_b64_tr_b16 v[18:19], v13 offset:24832
    s_waitcnt lgkmcnt(10)
    v_mfma_f32_32x32x16_bf16 v[52:67], v[20:23], a[76:79], v[52:67]
    ds_read_b64_tr_b16 v[20:21], v13 offset:25600
    ds_read_b64_tr_b16 v[22:23], v13 offset:25856
    s_waitcnt lgkmcnt(10)
    v_mfma_f32_32x32x16_bf16 v[52:67], v[24:27], a[80:83], v[52:67]
    ds_read_b64_tr_b16 v[24:25], v13 offset:26624
    ds_read_b64_tr_b16 v[26:27], v13 offset:26880
    s_waitcnt lgkmcnt(10)
    v_mfma_f32_32x32x16_bf16 v[52:67], v[28:31], a[84:87], v[52:67]
    ds_read_b64_tr_b16 v[28:29], v13 offset:27648
    ds_read_b64_tr_b16 v[30:31], v13 offset:27904
    s_waitcnt lgkmcnt(10)
    v_mfma_f32_32x32x16_bf16 v[52:67], v[32:35], a[88:91], v[52:67]
    ds_read_b64_tr_b16 v[32:33], v13 offset:36864
    ds_read_b64_tr_b16 v[34:35], v13 offset:37120
    s_waitcnt lgkmcnt(10)
    v_mfma_f32_32x32x16_bf16 v[52:67], v[36:39], a[92:95], v[52:67]
    ds_read_b64_tr_b16 v[36:37], v13 offset:37888
    ds_read_b64_tr_b16 v[38:39], v13 offset:38144
    s_waitcnt lgkmcnt(10)
    v_mfma_f32_32x32x16_bf16 v[52:67], v[16:19], a[96:99], v[52:67]
    ds_read_b64_tr_b16 v[16:17], v13 offset:38912
    ds_read_b64_tr_b16 v[18:19], v13 offset:39168
    s_waitcnt lgkmcnt(10)
    v_mfma_f32_32x32x16_bf16 v[52:67], v[20:23], a[100:103], v[52:67]
    ds_read_b64_tr_b16 v[20:21], v13 offset:39936
    ds_read_b64_tr_b16 v[22:23], v13 offset:40192
    s_waitcnt lgkmcnt(10)
    v_mfma_f32_32x32x16_bf16 v[52:67], v[24:27], a[104:107], v[52:67]
    s_waitcnt lgkmcnt(8)
    v_mfma_f32_32x32x16_bf16 v[52:67], v[28:31], a[108:111], v[52:67]
    s_waitcnt lgkmcnt(6)
    v_mfma_f32_32x32x16_bf16 v[52:67], v[32:35], a[112:115], v[52:67]
    s_waitcnt lgkmcnt(4)
    v_mfma_f32_32x32x16_bf16 v[52:67], v[36:39], a[116:119], v[52:67]
    s_waitcnt lgkmcnt(2)
    v_mfma_f32_32x32x16_bf16 v[52:67], v[16:19], a[120:123], v[52:67]
    s_waitcnt lgkmcnt(0)
    v_mfma_f32_32x32x16_bf16 v[52:67], v[20:23], a[124:127], v[52:67]
    s_setprio 3
    s_lshl_b32 s73, s62, 11
    s_add_u32 s73, s73, 122880
    v_add_u32 v3, s73, v2
    s_nop 7
    v_pk_mul_f32 v[16:17], v[52:53], s[8:9]
    v_pk_mul_f32 v[18:19], v[54:55], s[8:9]
    v_pk_mul_f32 v[20:21], v[56:57], s[8:9]
    v_pk_mul_f32 v[22:23], v[58:59], s[8:9]
    v_pk_mul_f32 v[24:25], v[60:61], s[8:9]
    v_pk_mul_f32 v[26:27], v[62:63], s[8:9]
    v_pk_mul_f32 v[28:29], v[64:65], s[8:9]
    v_pk_mul_f32 v[30:31], v[66:67], s[8:9]
    v_exp_f32 v16, v16 clamp
    v_max_f32 v52, s76, v52
    v_exp_f32 v17, v17 clamp
    v_max_f32 v53, s76, v53
    v_exp_f32 v18, v18 clamp
    v_max_f32 v54, s76, v54
    v_exp_f32 v19, v19 clamp
    v_max_f32 v55, s76, v55
    v_exp_f32 v20, v20 clamp
    v_max_f32 v56, s76, v56
    v_exp_f32 v21, v21 clamp
    v_max_f32 v57, s76, v57
    v_exp_f32 v22, v22 clamp
    v_max_f32 v58, s76, v58
    v_exp_f32 v23, v23 clamp
    v_max_f32 v59, s76, v59
    v_exp_f32 v24, v24 clamp
    v_max_f32 v60, s76, v60
    v_exp_f32 v25, v25 clamp
    v_max_f32 v61, s76, v61
    v_exp_f32 v26, v26 clamp
    v_max_f32 v62, s76, v62
    v_exp_f32 v27, v27 clamp
    v_max_f32 v63, s76, v63
    v_exp_f32 v28, v28 clamp
    v_max_f32 v64, s76, v64
    v_exp_f32 v29, v29 clamp
    v_max_f32 v65, s76, v65
    v_exp_f32 v30, v30 clamp
    v_max_f32 v66, s76, v66
    v_exp_f32 v31, v31 clamp
    v_max_f32 v67, s76, v67
    v_pk_add_f32 v[52:53], v[52:53], v[16:17]
    v_pk_add_f32 v[54:55], v[54:55], v[18:19]
    v_pk_add_f32 v[56:57], v[56:57], v[20:21]
    v_pk_add_f32 v[58:59], v[58:59], v[22:23]
    v_pk_add_f32 v[60:61], v[60:61], v[24:25]
    v_pk_add_f32 v[62:63], v[62:63], v[26:27]
    v_pk_add_f32 v[64:65], v[64:65], v[28:29]
    v_pk_add_f32 v[66:67], v[66:67], v[30:31]
    v_cvt_pk_bf16_f32 v16, v52, v53
    v_cvt_pk_bf16_f32 v17, v54, v55
    v_cvt_pk_bf16_f32 v18, v56, v57
    v_cvt_pk_bf16_f32 v19, v58, v59
    v_cvt_pk_bf16_f32 v20, v60, v61
    v_cvt_pk_bf16_f32 v21, v62, v63
    v_cvt_pk_bf16_f32 v22, v64, v65
    v_cvt_pk_bf16_f32 v23, v66, v67
    ds_write_b128 v3, v[16:19]
    ds_write_b128 v3, v[20:23] offset:1024
    s_lshl_b32 s73, s63, 10
    s_add_u32 s73, s73, 131072
    v_add_u32 v3, s73, v2
    s_and_b32 s74, s61, 2
    s_lshl_b32 s74, s74, 11
    v_add_u32 v5, s74, v3
    s_xor_b32 s74, s74, 4096
    v_add_u32 v3, s74, v3
    ds_read_b128 v[16:19], v5
    ds_read_b128 v[20:23], v5 offset:2048
    ds_read_b128 v[24:27], v3
    ds_read_b128 v[28:31], v3 offset:2048
    s_waitcnt lgkmcnt(0)
    v_mov_b32 v5, 1
    s_mov_b64 exec, 1
    ds_add_u32 v4, v5 offset:8
    s_mov_b64 exec, -1
    v_and_b32 v15, 15, v1
    v_lshrrev_b32 v3, 5, v1
    v_lshl_add_u32 v15, v3, 4, v15
    v_lshlrev_b32 v15, 4, v15
    v_add_u32 v15, 1024, v15
    v_mov_b32 v125, 0xdddddddd
    v_mov_b32 v56, 0
    v_mov_b32 v57, 0
    v_mov_b32 v58, 0
    v_mov_b32 v59, 0
    v_mov_b32 v60, 0
    v_mov_b32 v61, 0
    v_mov_b32 v62, 0
    v_mov_b32 v63, 0
    v_mov_b32 v124, 0
    s_mov_b32 exec_lo, 0x110000
    s_mov_b32 exec_hi, 0x110000
    v_mov_b32 v124, 0x3f803f80
    s_mov_b64 exec, -1
    v_accvgpr_write_b32 a84, v124
    v_accvgpr_write_b32 a85, v124
    v_accvgpr_write_b32 a86, v124
    v_accvgpr_write_b32 a87, v124
    v_accvgpr_write_b32 a88, v124
    v_accvgpr_write_b32 a89, v124
    v_accvgpr_write_b32 a90, v124
    v_accvgpr_write_b32 a91, v124
    v_accvgpr_write_b32 a92, v124
    v_accvgpr_write_b32 a93, v124
    v_accvgpr_write_b32 a94, v124
    v_accvgpr_write_b32 a95, v124
    v_accvgpr_write_b32 a96, v124
    v_accvgpr_write_b32 a97, v124
    v_accvgpr_write_b32 a98, v124
    v_accvgpr_write_b32 a99, v124
    v_accvgpr_write_b32 a100, v124
    v_accvgpr_write_b32 a101, v124
    v_accvgpr_write_b32 a102, v124
    v_accvgpr_write_b32 a103, v124
    v_accvgpr_write_b32 a104, v124
    v_accvgpr_write_b32 a105, v124
    v_accvgpr_write_b32 a106, v124
    v_accvgpr_write_b32 a107, v124
    v_accvgpr_write_b32 a108, v124
    v_accvgpr_write_b32 a109, v124
    v_accvgpr_write_b32 a110, v124
    v_accvgpr_write_b32 a111, v124
    v_accvgpr_write_b32 a112, v124
    v_accvgpr_write_b32 a113, v124
    v_accvgpr_write_b32 a114, v124
    v_accvgpr_write_b32 a115, v124
    v_accvgpr_write_b32 a116, v124
    v_accvgpr_write_b32 a117, v124
    v_accvgpr_write_b32 a118, v124
    v_accvgpr_write_b32 a119, v124
    v_accvgpr_write_b32 a120, v124
    v_accvgpr_write_b32 a121, v124
    v_accvgpr_write_b32 a122, v124
    v_accvgpr_write_b32 a123, v124
    v_mfma_f32_32x32x16_bf16 a[0:15], v[56:59], v[56:59], 0
    v_mfma_f32_32x32x16_bf16 a[16:31], v[56:59], v[56:59], 0
    v_mfma_f32_32x32x16_bf16 a[32:47], v[56:59], v[56:59], 0
    v_mfma_f32_32x32x16_bf16 a[48:63], v[56:59], v[56:59], 0
    s_lshr_b32 s73, s61, 1
    s_lshl_b32 s73, s73, 15
    s_lshl_b32 s74, s58, 18
    s_add_u32 s73, s73, s74
    s_lshl_b32 s74, s63, 17
    s_add_u32 s73, s73, s74
    s_add_u32 s73, s73, 1048576
    v_lshlrev_b32 v126, 4, v1
    v_add_u32 v126, s73, v126
    v_add_u32 v127, s73, v15
    s_mov_b32 s8, 0x76543210
    s_mov_b32 s9, 0xfedcba98
    s_lshl_b32 s73, s59, 2
    s_add_u32 s73, s73, 4
    s_sub_u32 s74, 64, s73
    s_lshr_b64 s[14:15], s[8:9], s73
    s_lshl_b64 s[8:9], s[8:9], s74
    s_or_b64 s[14:15], s[14:15], s[8:9]
    s_lshl_b32 s73, s59, 2
    s_and_b32 s74, s61, 2
    s_add_u32 s73, s73, s74
    s_lshl_b32 s73, s73, 5
    s_lshl_b32 s74, s58, 1
    s_add_u32 s73, s73, s74
    s_add_u32 s73, s73, s63
    s_lshl_b32 s76, s73, 10
    s_add_u32 s76, s76, 6291456
    s_lshl_b32 s77, s73, 3
    s_add_u32 s77, s77, 32768
    s_add_u32 s12, s76, 32768
    v_mov_b32 v8, -1
    v_mov_b32 v9, -1
    v_mov_b32 v10, -1
    v_mov_b32 v11, -1
    buffer_store_dwordx4 v[8:11], v2, s[52:55], s76 offen sc1
    buffer_store_dwordx4 v[8:11], v2, s[52:55], s12 offen sc1
    s_mov_b32 s7, 0
L_spin_34:
    ds_read_b32 v5, v4 offset:16
    s_waitcnt lgkmcnt(0)
    v_readfirstlane_b32 s72, v5
    s_add_u32 s7, s7, 1
    s_cmp_ge_u32 s72, 4
    s_cbranch_scc1 L_spun_35
    s_sleep 1
    s_cmp_lt_u32 s7, 65536
    s_cbranch_scc1 L_spin_34
L_spun_35:
    s_lshl_b32 s73, s58, 9
    s_lshr_b32 s74, s61, 1
    s_lshl_b32 s74, s74, 7
    s_add_u32 s73, s73, s74
    s_add_u32 s73, s73, 4096
    v_lshlrev_b32 v3, 3, v1
    s_mov_b32 s7, 0
    s_mov_b32 exec_lo, 0xffff
    s_mov_b32 exec_hi, 0x0
L_poll_36:
    buffer_load_dwordx2 v[4:5], v3, s[52:55], s73 offen sc1
    s_waitcnt vmcnt(0)
    v_cmp_ne_u64 vcc, s[56:57], v[4:5]
    s_add_u32 s7, s7, 1
    s_cmp_eq_u64 vcc, 0
    s_cbranch_scc1 L_polled_37
    s_sleep 2
    s_cmp_lt_u32 s7, 65536
    s_cbranch_scc1 L_poll_36
L_polled_37:
    s_mov_b64 exec, -1
    v_lshlrev_b32 v3, 8, v1
    v_mov_b32 v6, s56
    v_mov_b32 v7, s57
    s_mov_b64 exec, 0x3
    buffer_store_dwordx2 v[6:7], v3, s[52:55], s77 offen sc1
    s_mov_b64 exec, -1
    s_and_b32 s73, s61, 3
    s_mul_i32 s74, s73, 4608
    s_add_u32 s74, s74, 139264
    v_lshlrev_b32 v2, 4, v1
    v_lshlrev_b32 v3, 2, v1
    v_add_u32 v4, s74, v2
    v_add_u32 v5, s74, v3
    s_xor_b32 s73, s73, 2
    s_mul_i32 s74, s73, 4608
    s_add_u32 s74, s74, 139264
    v_add_u32 v6, s74, v2
    v_add_u32 v7, s74, v3
    s_mul_i32 s74, s63, 9216
    s_and_b32 s73, s61, 2
    s_mul_i32 s75, s73, 2304
    s_add_u32 s74, s74, s75
    s_add_u32 s74, s74, 65536
    v_add_u32 v8, s74, v2
    v_add_u32 v9, s74, v3
    s_and_b32 s3, s58, 3
    s_and_b32 s73, s61, 2
    s_sub_u32 s3, s3, s73
    s_lshl_b32 s73, s58, 1
    s_add_u32 s73, s73, s63
    s_lshl_b32 s73, s73, 10
    v_add_u32 v10, s73, v2
    s_setprio 1
    s_mov_b32 s79, 3
L_attn:
    s_lshl_b32 s78, s14, 11
    s_and_b32 s78, s78, 0x7800
    buffer_load_dwordx4 a[64:67], v126, s[52:55], s78 offen sc1
    s_mov_b64 exec, s[80:81]
    buffer_load_dwordx4 a[84:87], v127, s[52:55], s78 offen sc1
    buffer_load_dwordx4 a[88:91], v127, s[52:55], s78 offen offset:512 sc1
    s_mov_b64 exec, -1
    s_lshl_b32 s78, s14, 7
    s_and_b32 s78, s78, 0x7800
    buffer_load_dwordx4 a[68:71], v126, s[52:55], s78 offen sc1
    s_mov_b64 exec, s[80:81]
    buffer_load_dwordx4 a[92:95], v127, s[52:55], s78 offen sc1
    buffer_load_dwordx4 a[96:99], v127, s[52:55], s78 offen offset:512 sc1
    s_mov_b64 exec, -1
    s_lshl_b32 s78, s14, 3
    s_and_b32 s78, s78, 0x7800
    buffer_load_dwordx4 a[72:75], v126, s[52:55], s78 offen sc1
    s_mov_b64 exec, s[80:81]
    buffer_load_dwordx4 a[100:103], v127, s[52:55], s78 offen sc1
    buffer_load_dwordx4 a[104:107], v127, s[52:55], s78 offen offset:512 sc1
    s_mov_b64 exec, -1
    s_lshr_b32 s78, s14, 1
    s_and_b32 s78, s78, 0x7800
    buffer_load_dwordx4 a[76:79], v126, s[52:55], s78 offen sc1
    s_mov_b64 exec, s[80:81]
    buffer_load_dwordx4 a[108:111], v127, s[52:55], s78 offen sc1
    buffer_load_dwordx4 a[112:115], v127, s[52:55], s78 offen offset:512 sc1
    s_mov_b64 exec, -1
    s_lshr_b32 s78, s14, 5
    s_and_b32 s78, s78, 0x7800
    s_lshr_b64 s[14:15], s[14:15], 9
    s_waitcnt vmcnt(9)
    v_mfma_f32_32x32x16_bf16 v[32:47], a[64:67], v[16:19], 0
    s_nop 11
.p2align 3
L_loop:
    v_exp_f32 v32, v32
    v_exp_f32 v33, v33
    v_smfmac_f32_32x32x32_bf16 a[48:63], a[120:123], v[56:63], v125
    v_exp_f32 v34, v34
    buffer_load_dwordx4 a[80:83], v126, s[52:55], s78 offen sc1
    s_mov_b64 exec, s[80:81]
    buffer_load_dwordx4 a[116:119], v127, s[52:55], s78 offen sc1
    buffer_load_dwordx4 a[120:123], v127, s[52:55], s78 offen offset:512 sc1
    s_mov_b64 exec, -1
    s_and_b32 s78, s14, 0x7800
    s_lshr_b64 s[14:15], s[14:15], 4
    v_exp_f32 v35, v35
    v_exp_f32 v36, v36
    v_mfma_f32_32x32x16_bf16 v[48:63], a[64:67], v[20:23], 0
    v_exp_f32 v37, v37
    v_exp_f32 v38, v38
    v_exp_f32 v39, v39
    v_exp_f32 v40, v40
    v_exp_f32 v41, v41
    v_smfmac_f32_32x32x32_bf16 a[0:15], a[84:87], v[32:39], v125
    v_exp_f32 v42, v42
    v_exp_f32 v43, v43
    v_exp_f32 v44, v44
    v_exp_f32 v45, v45
    v_exp_f32 v46, v46
    v_exp_f32 v47, v47
    v_exp_f32 v48, v48
    v_exp_f32 v49, v49
    v_smfmac_f32_32x32x32_bf16 a[0:15], a[88:91], v[40:47], v125
    v_exp_f32 v50, v50
    v_exp_f32 v51, v51
    v_exp_f32 v52, v52
    v_mfma_f32_32x32x16_bf16 v[32:47], a[64:67], v[24:27], 0
    v_exp_f32 v53, v53
    v_exp_f32 v54, v54
    v_exp_f32 v55, v55
    v_exp_f32 v56, v56
    v_exp_f32 v57, v57
    v_smfmac_f32_32x32x32_bf16 a[16:31], a[84:87], v[48:55], v125
    v_exp_f32 v58, v58
    v_exp_f32 v59, v59
    v_exp_f32 v60, v60
    v_exp_f32 v61, v61
    v_exp_f32 v62, v62
    v_exp_f32 v63, v63
    v_exp_f32 v32, v32
    v_exp_f32 v33, v33
    v_smfmac_f32_32x32x32_bf16 a[16:31], a[88:91], v[56:63], v125
    v_exp_f32 v34, v34
    v_exp_f32 v35, v35
    v_exp_f32 v36, v36
    v_mfma_f32_32x32x16_bf16 v[48:63], a[64:67], v[28:31], 0
    v_exp_f32 v37, v37
    v_exp_f32 v38, v38
    v_exp_f32 v39, v39
    v_exp_f32 v40, v40
    v_exp_f32 v41, v41
    v_smfmac_f32_32x32x32_bf16 a[32:47], a[84:87], v[32:39], v125
    v_exp_f32 v42, v42
    v_exp_f32 v43, v43
    v_exp_f32 v44, v44
    v_exp_f32 v45, v45
    v_exp_f32 v46, v46
    v_exp_f32 v47, v47
    v_exp_f32 v48, v48
    v_exp_f32 v49, v49
    v_smfmac_f32_32x32x32_bf16 a[32:47], a[88:91], v[40:47], v125
    v_exp_f32 v50, v50
    v_exp_f32 v51, v51
    v_exp_f32 v52, v52
    s_waitcnt vmcnt(9)
    v_mfma_f32_32x32x16_bf16 v[32:47], a[68:71], v[16:19], 0
    v_exp_f32 v53, v53
    v_exp_f32 v54, v54
    v_exp_f32 v55, v55
    v_exp_f32 v56, v56
    v_exp_f32 v57, v57
    v_smfmac_f32_32x32x32_bf16 a[48:63], a[84:87], v[48:55], v125
    v_exp_f32 v58, v58
    v_exp_f32 v59, v59
    v_exp_f32 v60, v60
    v_exp_f32 v61, v61
    v_exp_f32 v62, v62
    v_exp_f32 v63, v63
    v_exp_f32 v32, v32
    v_exp_f32 v33, v33
    v_smfmac_f32_32x32x32_bf16 a[48:63], a[88:91], v[56:63], v125
    v_exp_f32 v34, v34
    buffer_load_dwordx4 a[64:67], v126, s[52:55], s78 offen sc1
    s_mov_b64 exec, s[80:81]
    buffer_load_dwordx4 a[84:87], v127, s[52:55], s78 offen sc1
    buffer_load_dwordx4 a[88:91], v127, s[52:55], s78 offen offset:512 sc1
    s_mov_b64 exec, -1
    s_and_b32 s78, s14, 0x7800
    s_lshr_b64 s[14:15], s[14:15], 4
    v_exp_f32 v35, v35
    v_exp_f32 v36, v36
    v_mfma_f32_32x32x16_bf16 v[48:63], a[68:71], v[20:23], 0
    v_exp_f32 v37, v37
    v_exp_f32 v38, v38
    v_exp_f32 v39, v39
    v_exp_f32 v40, v40
    v_exp_f32 v41, v41
    v_smfmac_f32_32x32x32_bf16 a[0:15], a[92:95], v[32:39], v125
    v_exp_f32 v42, v42
    v_exp_f32 v43, v43
    v_exp_f32 v44, v44
    v_exp_f32 v45, v45
    v_exp_f32 v46, v46
    v_exp_f32 v47, v47
    v_exp_f32 v48, v48
    v_exp_f32 v49, v49
    v_smfmac_f32_32x32x32_bf16 a[0:15], a[96:99], v[40:47], v125
    v_exp_f32 v50, v50
    v_exp_f32 v51, v51
    v_exp_f32 v52, v52
    v_mfma_f32_32x32x16_bf16 v[32:47], a[68:71], v[24:27], 0
    v_exp_f32 v53, v53
    v_exp_f32 v54, v54
    v_exp_f32 v55, v55
    v_exp_f32 v56, v56
    v_exp_f32 v57, v57
    v_smfmac_f32_32x32x32_bf16 a[16:31], a[92:95], v[48:55], v125
    v_exp_f32 v58, v58
    v_exp_f32 v59, v59
    v_exp_f32 v60, v60
    v_exp_f32 v61, v61
    v_exp_f32 v62, v62
    v_exp_f32 v63, v63
    v_exp_f32 v32, v32
    v_exp_f32 v33, v33
    v_smfmac_f32_32x32x32_bf16 a[16:31], a[96:99], v[56:63], v125
    v_exp_f32 v34, v34
    v_exp_f32 v35, v35
    v_exp_f32 v36, v36
    v_mfma_f32_32x32x16_bf16 v[48:63], a[68:71], v[28:31], 0
    v_exp_f32 v37, v37
    v_exp_f32 v38, v38
    v_exp_f32 v39, v39
    v_exp_f32 v40, v40
    v_exp_f32 v41, v41
    v_smfmac_f32_32x32x32_bf16 a[32:47], a[92:95], v[32:39], v125
    v_exp_f32 v42, v42
    v_exp_f32 v43, v43
    v_exp_f32 v44, v44
    v_exp_f32 v45, v45
    v_exp_f32 v46, v46
    v_exp_f32 v47, v47
    v_exp_f32 v48, v48
    v_exp_f32 v49, v49
    v_smfmac_f32_32x32x32_bf16 a[32:47], a[96:99], v[40:47], v125
    v_exp_f32 v50, v50
    v_exp_f32 v51, v51
    v_exp_f32 v52, v52
    s_waitcnt vmcnt(9)
    v_mfma_f32_32x32x16_bf16 v[32:47], a[72:75], v[16:19], 0
    v_exp_f32 v53, v53
    v_exp_f32 v54, v54
    v_exp_f32 v55, v55
    v_exp_f32 v56, v56
    v_exp_f32 v57, v57
    v_smfmac_f32_32x32x32_bf16 a[48:63], a[92:95], v[48:55], v125
    v_exp_f32 v58, v58
    v_exp_f32 v59, v59
    v_exp_f32 v60, v60
    v_exp_f32 v61, v61
    v_exp_f32 v62, v62
    v_exp_f32 v63, v63
    v_exp_f32 v32, v32
    v_exp_f32 v33, v33
    v_smfmac_f32_32x32x32_bf16 a[48:63], a[96:99], v[56:63], v125
    v_exp_f32 v34, v34
    buffer_load_dwordx4 a[68:71], v126, s[52:55], s78 offen sc1
    s_mov_b64 exec, s[80:81]
    buffer_load_dwordx4 a[92:95], v127, s[52:55], s78 offen sc1
    buffer_load_dwordx4 a[96:99], v127, s[52:55], s78 offen offset:512 sc1
    s_mov_b64 exec, -1
    s_and_b32 s78, s14, 0x7800
    s_lshr_b64 s[14:15], s[14:15], 4
    v_exp_f32 v35, v35
    v_exp_f32 v36, v36
    v_mfma_f32_32x32x16_bf16 v[48:63], a[72:75], v[20:23], 0
    v_exp_f32 v37, v37
    v_exp_f32 v38, v38
    v_exp_f32 v39, v39
    v_exp_f32 v40, v40
    v_exp_f32 v41, v41
    v_smfmac_f32_32x32x32_bf16 a[0:15], a[100:103], v[32:39], v125
    v_exp_f32 v42, v42
    v_exp_f32 v43, v43
    v_exp_f32 v44, v44
    v_exp_f32 v45, v45
    v_exp_f32 v46, v46
    v_exp_f32 v47, v47
    v_exp_f32 v48, v48
    v_exp_f32 v49, v49
    v_smfmac_f32_32x32x32_bf16 a[0:15], a[104:107], v[40:47], v125
    v_exp_f32 v50, v50
    v_exp_f32 v51, v51
    v_exp_f32 v52, v52
    v_mfma_f32_32x32x16_bf16 v[32:47], a[72:75], v[24:27], 0
    v_exp_f32 v53, v53
    v_exp_f32 v54, v54
    v_exp_f32 v55, v55
    v_exp_f32 v56, v56
    v_exp_f32 v57, v57
    v_smfmac_f32_32x32x32_bf16 a[16:31], a[100:103], v[48:55], v125
    v_exp_f32 v58, v58
    v_exp_f32 v59, v59
    v_exp_f32 v60, v60
    v_exp_f32 v61, v61
    v_exp_f32 v62, v62
    v_exp_f32 v63, v63
    v_exp_f32 v32, v32
    v_exp_f32 v33, v33
    v_smfmac_f32_32x32x32_bf16 a[16:31], a[104:107], v[56:63], v125
    v_exp_f32 v34, v34
    v_exp_f32 v35, v35
    v_exp_f32 v36, v36
    v_mfma_f32_32x32x16_bf16 v[48:63], a[72:75], v[28:31], 0
    v_exp_f32 v37, v37
    v_exp_f32 v38, v38
    v_exp_f32 v39, v39
    v_exp_f32 v40, v40
    v_exp_f32 v41, v41
    v_smfmac_f32_32x32x32_bf16 a[32:47], a[100:103], v[32:39], v125
    v_exp_f32 v42, v42
    v_exp_f32 v43, v43
    v_exp_f32 v44, v44
    v_exp_f32 v45, v45
    v_exp_f32 v46, v46
    v_exp_f32 v47, v47
    v_exp_f32 v48, v48
    v_exp_f32 v49, v49
    v_smfmac_f32_32x32x32_bf16 a[32:47], a[104:107], v[40:47], v125
    v_exp_f32 v50, v50
    v_exp_f32 v51, v51
    v_exp_f32 v52, v52
    s_waitcnt vmcnt(9)
    v_mfma_f32_32x32x16_bf16 v[32:47], a[76:79], v[16:19], 0
    v_exp_f32 v53, v53
    v_exp_f32 v54, v54
    v_exp_f32 v55, v55
    v_exp_f32 v56, v56
    v_exp_f32 v57, v57
    v_smfmac_f32_32x32x32_bf16 a[48:63], a[100:103], v[48:55], v125
    v_exp_f32 v58, v58
    v_exp_f32 v59, v59
    v_exp_f32 v60, v60
    v_exp_f32 v61, v61
    v_exp_f32 v62, v62
    v_exp_f32 v63, v63
    v_exp_f32 v32, v32
    v_exp_f32 v33, v33
    v_smfmac_f32_32x32x32_bf16 a[48:63], a[104:107], v[56:63], v125
    v_exp_f32 v34, v34
    buffer_load_dwordx4 a[72:75], v126, s[52:55], s78 offen sc1
    s_mov_b64 exec, s[80:81]
    buffer_load_dwordx4 a[100:103], v127, s[52:55], s78 offen sc1
    buffer_load_dwordx4 a[104:107], v127, s[52:55], s78 offen offset:512 sc1
    s_mov_b64 exec, -1
    s_and_b32 s78, s14, 0x7800
    s_lshr_b64 s[14:15], s[14:15], 4
    v_exp_f32 v35, v35
    v_exp_f32 v36, v36
    v_mfma_f32_32x32x16_bf16 v[48:63], a[76:79], v[20:23], 0
    v_exp_f32 v37, v37
    v_exp_f32 v38, v38
    v_exp_f32 v39, v39
    v_exp_f32 v40, v40
    v_exp_f32 v41, v41
    v_smfmac_f32_32x32x32_bf16 a[0:15], a[108:111], v[32:39], v125
    v_exp_f32 v42, v42
    v_exp_f32 v43, v43
    v_exp_f32 v44, v44
    v_exp_f32 v45, v45
    v_exp_f32 v46, v46
    v_exp_f32 v47, v47
    v_exp_f32 v48, v48
    v_exp_f32 v49, v49
    v_smfmac_f32_32x32x32_bf16 a[0:15], a[112:115], v[40:47], v125
    v_exp_f32 v50, v50
    v_exp_f32 v51, v51
    v_exp_f32 v52, v52
    v_mfma_f32_32x32x16_bf16 v[32:47], a[76:79], v[24:27], 0
    v_exp_f32 v53, v53
    v_exp_f32 v54, v54
    v_exp_f32 v55, v55
    v_exp_f32 v56, v56
    v_exp_f32 v57, v57
    v_smfmac_f32_32x32x32_bf16 a[16:31], a[108:111], v[48:55], v125
    v_exp_f32 v58, v58
    v_exp_f32 v59, v59
    v_exp_f32 v60, v60
    v_exp_f32 v61, v61
    v_exp_f32 v62, v62
    v_exp_f32 v63, v63
    v_exp_f32 v32, v32
    v_exp_f32 v33, v33
    v_smfmac_f32_32x32x32_bf16 a[16:31], a[112:115], v[56:63], v125
    v_exp_f32 v34, v34
    v_exp_f32 v35, v35
    v_exp_f32 v36, v36
    v_mfma_f32_32x32x16_bf16 v[48:63], a[76:79], v[28:31], 0
    v_exp_f32 v37, v37
    v_exp_f32 v38, v38
    v_exp_f32 v39, v39
    v_exp_f32 v40, v40
    v_exp_f32 v41, v41
    v_smfmac_f32_32x32x32_bf16 a[32:47], a[108:111], v[32:39], v125
    v_exp_f32 v42, v42
    v_exp_f32 v43, v43
    v_exp_f32 v44, v44
    v_exp_f32 v45, v45
    v_exp_f32 v46, v46
    v_exp_f32 v47, v47
    v_exp_f32 v48, v48
    v_exp_f32 v49, v49
    v_smfmac_f32_32x32x32_bf16 a[32:47], a[112:115], v[40:47], v125
    v_exp_f32 v50, v50
    v_exp_f32 v51, v51
    v_exp_f32 v52, v52
    s_waitcnt vmcnt(9)
    v_mfma_f32_32x32x16_bf16 v[32:47], a[80:83], v[16:19], 0
    v_exp_f32 v53, v53
    v_exp_f32 v54, v54
    v_exp_f32 v55, v55
    v_exp_f32 v56, v56
    v_exp_f32 v57, v57
    v_smfmac_f32_32x32x32_bf16 a[48:63], a[108:111], v[48:55], v125
    v_exp_f32 v58, v58
    v_exp_f32 v59, v59
    v_exp_f32 v60, v60
    v_exp_f32 v61, v61
    v_exp_f32 v62, v62
    v_exp_f32 v63, v63
    v_exp_f32 v32, v32
    v_exp_f32 v33, v33
    v_smfmac_f32_32x32x32_bf16 a[48:63], a[112:115], v[56:63], v125
    v_exp_f32 v34, v34
    buffer_load_dwordx4 a[76:79], v126, s[52:55], s78 offen sc1
    s_mov_b64 exec, s[80:81]
    buffer_load_dwordx4 a[108:111], v127, s[52:55], s78 offen sc1
    buffer_load_dwordx4 a[112:115], v127, s[52:55], s78 offen offset:512 sc1
    s_mov_b64 exec, -1
    s_and_b32 s78, s14, 0x7800
    s_lshr_b64 s[14:15], s[14:15], 4
    v_exp_f32 v35, v35
    v_exp_f32 v36, v36
    v_mfma_f32_32x32x16_bf16 v[48:63], a[80:83], v[20:23], 0
    v_exp_f32 v37, v37
    v_exp_f32 v38, v38
    v_exp_f32 v39, v39
    v_exp_f32 v40, v40
    v_exp_f32 v41, v41
    v_smfmac_f32_32x32x32_bf16 a[0:15], a[116:119], v[32:39], v125
    v_exp_f32 v42, v42
    v_exp_f32 v43, v43
    v_exp_f32 v44, v44
    v_exp_f32 v45, v45
    v_exp_f32 v46, v46
    v_exp_f32 v47, v47
    v_exp_f32 v48, v48
    v_exp_f32 v49, v49
    v_smfmac_f32_32x32x32_bf16 a[0:15], a[120:123], v[40:47], v125
    v_exp_f32 v50, v50
    v_exp_f32 v51, v51
    v_exp_f32 v52, v52
    v_mfma_f32_32x32x16_bf16 v[32:47], a[80:83], v[24:27], 0
    v_exp_f32 v53, v53
    v_exp_f32 v54, v54
    v_exp_f32 v55, v55
    v_exp_f32 v56, v56
    v_exp_f32 v57, v57
    v_smfmac_f32_32x32x32_bf16 a[16:31], a[116:119], v[48:55], v125
    v_exp_f32 v58, v58
    v_exp_f32 v59, v59
    v_exp_f32 v60, v60
    v_exp_f32 v61, v61
    v_exp_f32 v62, v62
    v_exp_f32 v63, v63
    v_exp_f32 v32, v32
    v_exp_f32 v33, v33
    v_smfmac_f32_32x32x32_bf16 a[16:31], a[120:123], v[56:63], v125
    v_exp_f32 v34, v34
    v_exp_f32 v35, v35
    v_exp_f32 v36, v36
    v_mfma_f32_32x32x16_bf16 v[48:63], a[80:83], v[28:31], 0
    v_exp_f32 v37, v37
    v_exp_f32 v38, v38
    v_exp_f32 v39, v39
    v_exp_f32 v40, v40
    v_exp_f32 v41, v41
    v_smfmac_f32_32x32x32_bf16 a[32:47], a[116:119], v[32:39], v125
    v_exp_f32 v42, v42
    v_exp_f32 v43, v43
    v_exp_f32 v44, v44
    v_exp_f32 v45, v45
    v_exp_f32 v46, v46
    v_exp_f32 v47, v47
    v_exp_f32 v48, v48
    v_exp_f32 v49, v49
    v_smfmac_f32_32x32x32_bf16 a[32:47], a[120:123], v[40:47], v125
    v_exp_f32 v50, v50
    v_exp_f32 v51, v51
    v_exp_f32 v52, v52
    s_waitcnt vmcnt(9)
    v_mfma_f32_32x32x16_bf16 v[32:47], a[64:67], v[16:19], 0
    v_exp_f32 v53, v53
    v_exp_f32 v54, v54
    v_exp_f32 v55, v55
    v_exp_f32 v56, v56
    v_exp_f32 v57, v57
    v_smfmac_f32_32x32x32_bf16 a[48:63], a[116:119], v[48:55], v125
    v_exp_f32 v58, v58
    v_exp_f32 v59, v59
    s_sub_u32 s79, s79, 1
    s_cmp_lg_u32 s79, 0
    v_exp_f32 v60, v60
    v_exp_f32 v61, v61
    v_exp_f32 v62, v62
    v_exp_f32 v63, v63
    s_cbranch_scc1 L_loop
    s_nop 1
    v_smfmac_f32_32x32x32_bf16 a[48:63], a[120:123], v[56:63], v125
    s_cmp_ge_u32 s61, 4
    s_cbranch_scc1 L_bfinal
    s_setprio 3
    v_mov_b32 v14, 161792
    v_lshlrev_b32 v2, 4, v1
    v_lshlrev_b32 v3, 3, v1
    v_mov_b32 v124, 0x3f80
    s_and_b32 s11, s58, 3
    s_lshl_b32 s74, s59, 2
    s_add_u32 s11, s11, s74
    s_and_b32 s12, s58, 12
    s_add_u32 s12, s12, s61
    s_lshl_b32 s74, s12, 9
    s_add_u32 s74, s74, 49152
    s_lshl_b32 s77, s12, 16
    s_add_u32 s77, s77, 10485760
    s_lshl_b32 s12, s12, 6
    s_lshl_b32 s73, s58, 7
    s_add_u32 s73, s73, 12288
    buffer_load_dwordx2 v[16:17], v3, s[52:55], s74 offen sc1
    s_mov_b32 s7, 0
L_spin_38:
    ds_read_b32 v5, v14 offset:8
    s_waitcnt lgkmcnt(0)
    v_readfirstlane_b32 s72, v5
    s_add_u32 s7, s7, 1
    s_cmp_ge_u32 s72, 4
    s_cbranch_scc1 L_spun_39
    s_sleep 1
    s_cmp_lt_u32 s7, 65536
    s_cbranch_scc1 L_spin_38
L_spun_39:
    s_mul_i32 s75, s61, 9216
    s_add_u32 s75, s75, 65536
    v_add_u32 v8, s75, v2
    v_lshlrev_b32 v9, 2, v1
    v_add_u32 v9, s75, v9
    ds_write_b128 v8, a[0:3] offset:0
    ds_write_b128 v8, a[4:7] offset:1024
    ds_write_b32 v9, a8 offset:2048
    ds_write_b128 v8, a[16:19] offset:2304
    ds_write_b128 v8, a[20:23] offset:3328
    ds_write_b32 v9, a24 offset:4352
    ds_write_b128 v8, a[32:35] offset:4608
    ds_write_b128 v8, a[36:39] offset:5632
    ds_write_b32 v9, a40 offset:6656
    ds_write_b128 v8, a[48:51] offset:6912
    ds_write_b128 v8, a[52:55] offset:7936
    ds_write_b32 v9, a56 offset:8960
    s_lshl_b32 s75, s61, 11
    s_add_u32 s75, s75, 122880
    v_add_u32 v12, s75, v2
    ds_read_b128 v[4:7], v12
    ds_read_b128 v[8:11], v12 offset:1024
    v_and_b32 v12, 1, v1
    v_lshlrev_b32 v12, 4, v12
    v_lshlrev_b32 v12, v12, v124
    s_mov_b32 s8, 0x3
    s_mov_b32 s9, 0x30
    v_cndmask_b32 v68, 0, v12, s[8:9]
    s_mov_b32 s8, 0xc
    s_mov_b32 s9, 0xc0
    v_cndmask_b32 v69, 0, v12, s[8:9]
    s_mov_b32 s8, 0x300
    s_mov_b32 s9, 0x3000
    v_cndmask_b32 v70, 0, v12, s[8:9]
    s_mov_b32 s8, 0xc00
    s_mov_b32 s9, 0xc000
    v_cndmask_b32 v71, 0, v12, s[8:9]
    s_mov_b32 s7, 0
    s_mov_b32 exec_lo, 0xffff
    s_mov_b32 exec_hi, 0x0
L_poll_40:
    buffer_load_dwordx2 v[12:13], v3, s[52:55], s73 offen sc1
    s_waitcnt vmcnt(0)
    v_cmp_ne_u64 vcc, s[56:57], v[12:13]
    s_add_u32 s7, s7, 1
    s_cmp_eq_u64 vcc, 0
    s_cbranch_scc1 L_polled_41
    s_sleep 2
    s_cmp_lt_u32 s7, 65536
    s_cbranch_scc1 L_poll_40
L_polled_41:
    s_mov_b64 exec, -1
    v_cmp_ne_u64 vcc, s[56:57], v[16:17]
    s_cmp_eq_u64 vcc, 0
    s_cbranch_scc1 L_wok_42
    s_mov_b32 s7, 0
    s_mov_b32 exec_lo, 0xffffffff
    s_mov_b32 exec_hi, 0xffffffff
L_poll_43:
    buffer_load_dwordx2 v[12:13], v3, s[52:55], s74 offen sc1
    s_waitcnt vmcnt(0)
    v_cmp_ne_u64 vcc, s[56:57], v[12:13]
    s_add_u32 s7, s7, 1
    s_cmp_eq_u64 vcc, 0
    s_cbranch_scc1 L_polled_44
    s_sleep 2
    s_cmp_lt_u32 s7, 65536
    s_cbranch_scc1 L_poll_43
L_polled_44:
    s_mov_b64 exec, -1
L_wok_42:
    s_lshl_b32 s76, s58, 15
    s_lshl_b32 s74, s63, 14
    s_add_u32 s76, s76, s74
    s_lshr_b32 s74, s61, 1
    s_lshl_b32 s74, s74, 13
    s_add_u32 s76, s76, s74
    s_add_u32 s76, s76, 5242880
    s_setprio 0
    buffer_load_dwordx4 v[72:75], v2, s[52:55], s76 offen offset:0 sc1
    buffer_load_dwordx4 v[76:79], v2, s[52:55], s76 offen offset:1024 sc1
    buffer_load_dwordx4 v[80:83], v2, s[52:55], s76 offen offset:2048 sc1
    buffer_load_dwordx4 v[84:87], v2, s[52:55], s76 offen offset:3072 sc1
    s_add_u32 s76, s76, 4096
    buffer_load_dwordx4 v[88:91], v2, s[52:55], s76 offen offset:0 sc1
    buffer_load_dwordx4 v[92:95], v2, s[52:55], s76 offen offset:1024 sc1
    buffer_load_dwordx4 v[96:99], v2, s[52:55], s76 offen offset:2048 sc1
    buffer_load_dwordx4 v[100:103], v2, s[52:55], s76 offen offset:3072 sc1
    s_waitcnt lgkmcnt(0)
    s_add_u32 s72, s77, 32768
    buffer_load_dwordx4 a[0:3], v2, s[52:55], s72 offen offset:0 sc1
    s_sleep 2
    s_add_u32 s72, s77, 32768
    buffer_load_dwordx4 a[4:7], v2, s[52:55], s72 offen offset:1024 sc1
    s_sleep 2
    s_add_u32 s72, s77, 32768
    buffer_load_dwordx4 a[8:11], v2, s[52:55], s72 offen offset:2048 sc1
    s_sleep 2
    s_add_u32 s72, s77, 32768
    buffer_load_dwordx4 a[12:15], v2, s[52:55], s72 offen offset:3072 sc1
    s_sleep 2
    s_add_u32 s72, s77, 36864
    buffer_load_dwordx4 a[16:19], v2, s[52:55], s72 offen offset:0 sc1
    s_sleep 2
    s_add_u32 s72, s77, 36864
    buffer_load_dwordx4 a[20:23], v2, s[52:55], s72 offen offset:1024 sc1
    s_sleep 2
    s_add_u32 s72, s77, 36864
    buffer_load_dwordx4 a[24:27], v2, s[52:55], s72 offen offset:2048 sc1
    s_sleep 2
    s_add_u32 s72, s77, 36864
    buffer_load_dwordx4 a[28:31], v2, s[52:55], s72 offen offset:3072 sc1
    s_sleep 2
    s_setprio 3
    s_lshl_b32 s73, s59, 2
    s_add_u32 s73, s73, s61
    s_lshl_b32 s73, s73, 5
    s_lshl_b32 s74, s58, 1
    s_add_u32 s73, s73, s74
    s_lshl_b32 s74, s73, 10
    s_add_u32 s74, s74, 8388608
    s_lshl_b32 s73, s73, 3
    s_add_u32 s73, s73, 16384
    s_mov_b32 s75, 0x358637bd
    s_lshl_b32 s76, s61, 11
    s_add_u32 s76, s76, 32768
    v_add_u32 v12, s76, v2
    v_add_u32 v13, 32768, v2
    s_waitcnt vmcnt(15)
    v_mfma_f32_32x32x16_bf16 v[104:119], v[68:71], v[72:75], 0
    s_waitcnt vmcnt(14)
    v_mfma_f32_32x32x16_bf16 v[104:119], v[68:71], v[76:79], v[104:119]
    s_waitcnt vmcnt(13)
    v_mfma_f32_32x32x16_bf16 v[104:119], v[68:71], v[80:83], v[104:119]
    s_waitcnt vmcnt(12)
    v_mfma_f32_32x32x16_bf16 v[104:119], v[68:71], v[84:87], v[104:119]
    s_waitcnt vmcnt(11)
    v_mfma_f32_32x32x16_bf16 v[104:119], v[68:71], v[88:91], v[104:119]
    s_waitcnt vmcnt(10)
    v_mfma_f32_32x32x16_bf16 v[104:119], v[68:71], v[92:95], v[104:119]
    s_waitcnt vmcnt(9)
    v_mfma_f32_32x32x16_bf16 v[104:119], v[68:71], v[96:99], v[104:119]
    s_waitcnt vmcnt(8)
    v_mfma_f32_32x32x16_bf16 v[104:119], v[68:71], v[100:103], v[104:119]
    s_nop 11
    ds_write_b128 v12, v[104:107]
    ds_write_b128 v12, v[108:111] offset:1024
    s_waitcnt lgkmcnt(0)
    v_mov_b32 v12, 1
    s_mov_b64 exec, 1
    ds_add_u32 v14, v12 offset:12
    s_mov_b64 exec, -1
    s_mov_b32 s7, 0
L_spin_45:
    ds_read_b32 v12, v14 offset:12
    s_waitcnt lgkmcnt(0)
    v_readfirstlane_b32 s72, v12
    s_add_u32 s7, s7, 1
    s_cmp_ge_u32 s72, 4
    s_cbranch_scc1 L_spun_46
    s_sleep 1
    s_cmp_lt_u32 s7, 65536
    s_cbranch_scc1 L_spin_45
L_spun_46:
    ds_read_b128 v[72:75], v13 offset:0
    ds_read_b128 v[76:79], v13 offset:1024
    ds_read_b128 v[80:83], v13 offset:2048
    ds_read_b128 v[84:87], v13 offset:3072
    ds_read_b128 v[88:91], v13 offset:4096
    ds_read_b128 v[92:95], v13 offset:5120
    ds_read_b128 v[96:99], v13 offset:6144
    ds_read_b128 v[100:103], v13 offset:7168
    s_waitcnt lgkmcnt(0)
    v_pk_add_f32 v[72:73], v[72:73], v[88:89]
    v_pk_add_f32 v[74:75], v[74:75], v[90:91]
    v_pk_add_f32 v[76:77], v[76:77], v[92:93]
    v_pk_add_f32 v[78:79], v[78:79], v[94:95]
    v_pk_add_f32 v[80:81], v[80:81], v[96:97]
    v_pk_add_f32 v[82:83], v[82:83], v[98:99]
    v_pk_add_f32 v[84:85], v[84:85], v[100:101]
    v_pk_add_f32 v[86:87], v[86:87], v[102:103]
    v_cvt_pk_bf16_f32 v64, v72, v73
    v_cvt_pk_bf16_f32 v65, v74, v75
    v_cvt_pk_bf16_f32 v66, v76, v77
    v_cvt_pk_bf16_f32 v67, v78, v79
    v_cvt_pk_bf16_f32 v68, v80, v81
    v_cvt_pk_bf16_f32 v69, v82, v83
    v_cvt_pk_bf16_f32 v70, v84, v85
    v_cvt_pk_bf16_f32 v71, v86, v87
    s_nop 1
    v_mfma_f32_32x32x16_bf16 v[16:31], v[64:67], v[4:7], 0
    v_mfma_f32_32x32x16_bf16 v[32:47], v[68:71], v[8:11], 0
    s_nop 10
    v_add_f32 v12, s75, v24
    v_add_f32 v13, s75, v32
    v_rcp_f32 v12, v12
    v_rcp_f32 v13, v13
    s_nop 0
    v_mul_f32 v16, v12, v16
    v_mul_f32 v40, v13, v40
    v_mul_f32 v17, v12, v17
    v_mul_f32 v41, v13, v41
    v_mul_f32 v18, v12, v18
    v_mul_f32 v42, v13, v42
    v_mul_f32 v19, v12, v19
    v_mul_f32 v43, v13, v43
    v_mul_f32 v20, v12, v20
    v_mul_f32 v44, v13, v44
    v_mul_f32 v21, v12, v21
    v_mul_f32 v45, v13, v45
    v_mul_f32 v22, v12, v22
    v_mul_f32 v46, v13, v46
    v_mul_f32 v23, v12, v23
    v_mul_f32 v47, v13, v47
    v_cvt_pk_bf16_f32 v64, v16, v17
    v_cvt_pk_bf16_f32 v65, v18, v19
    v_cvt_pk_bf16_f32 v66, v20, v21
    v_cvt_pk_bf16_f32 v67, v22, v23
    buffer_store_dwordx4 v[64:67], v2, s[52:55], s74 offen offset:0 sc1
    v_cvt_pk_bf16_f32 v68, v40, v41
    v_cvt_pk_bf16_f32 v69, v42, v43
    v_cvt_pk_bf16_f32 v70, v44, v45
    v_cvt_pk_bf16_f32 v71, v46, v47
    buffer_store_dwordx4 v[68:71], v2, s[52:55], s74 offen offset:1024 sc1
    s_mul_i32 s5, s61, 5120
    s_add_u32 s5, s5, 102400
    s_setprio 0
    s_add_u32 s72, s77, 40960
    buffer_load_dwordx4 a[32:35], v2, s[52:55], s72 offen offset:0 sc1
    s_sleep 2
    s_add_u32 s72, s77, 40960
    buffer_load_dwordx4 a[36:39], v2, s[52:55], s72 offen offset:1024 sc1
    s_sleep 2
    s_add_u32 s72, s77, 40960
    buffer_load_dwordx4 a[40:43], v2, s[52:55], s72 offen offset:2048 sc1
    s_sleep 2
    s_add_u32 s72, s77, 40960
    buffer_load_dwordx4 a[44:47], v2, s[52:55], s72 offen offset:3072 sc1
    s_sleep 2
    s_add_u32 s72, s77, 45056
    buffer_load_dwordx4 a[48:51], v2, s[52:55], s72 offen offset:0 sc1
    s_sleep 2
    s_add_u32 s72, s77, 45056
    buffer_load_dwordx4 a[52:55], v2, s[52:55], s72 offen offset:1024 sc1
    s_sleep 2
    s_add_u32 s72, s77, 45056
    buffer_load_dwordx4 a[56:59], v2, s[52:55], s72 offen offset:2048 sc1
    s_sleep 2
    s_add_u32 s72, s77, 45056
    buffer_load_dwordx4 a[60:63], v2, s[52:55], s72 offen offset:3072 sc1
    s_sleep 2
    s_add_u32 s72, s77, 49152
    buffer_load_dwordx4 a[64:67], v2, s[52:55], s72 offen offset:0 sc1
    s_sleep 2
    s_add_u32 s72, s77, 49152
    buffer_load_dwordx4 a[68:71], v2, s[52:55], s72 offen offset:1024 sc1
    s_sleep 2
    s_add_u32 s72, s77, 49152
    buffer_load_dwordx4 a[72:75], v2, s[52:55], s72 offen offset:2048 sc1
    s_sleep 2
    s_setprio 3
    s_waitcnt vmcnt(11)
    v_mov_b32 v12, s56
    v_mov_b32 v13, s57
    s_mov_b64 exec, 0x3
    buffer_store_dwordx2 v[12:13], v3, s[52:55], s73 offen sc1
    s_mov_b64 exec, -1
    s_setprio 0
    s_add_u32 s72, s77, 49152
    buffer_load_dwordx4 a[76:79], v2, s[52:55], s72 offen offset:3072 sc1
    s_sleep 2
    s_add_u32 s72, s77, 53248
    buffer_load_dwordx4 a[80:83], v2, s[52:55], s72 offen offset:0 sc1
    s_sleep 2
    s_add_u32 s72, s77, 53248
    buffer_load_dwordx4 a[84:87], v2, s[52:55], s72 offen offset:1024 sc1
    s_sleep 2
    s_add_u32 s72, s77, 53248
    buffer_load_dwordx4 a[88:91], v2, s[52:55], s72 offen offset:2048 sc1
    s_sleep 2
    s_add_u32 s72, s77, 53248
    buffer_load_dwordx4 a[92:95], v2, s[52:55], s72 offen offset:3072 sc1
    s_sleep 2
    s_add_u32 s72, s77, 57344
    buffer_load_dwordx4 a[96:99], v2, s[52:55], s72 offen offset:0 sc1
    s_sleep 2
    s_add_u32 s72, s77, 57344
    buffer_load_dwordx4 a[100:103], v2, s[52:55], s72 offen offset:1024 sc1
    s_sleep 2
    s_add_u32 s72, s77, 57344
    buffer_load_dwordx4 a[104:107], v2, s[52:55], s72 offen offset:2048 sc1
    s_sleep 2
    s_add_u32 s72, s77, 57344
    buffer_load_dwordx4 a[108:111], v2, s[52:55], s72 offen offset:3072 sc1
    s_sleep 2
    s_add_u32 s72, s77, 61440
    buffer_load_dwordx4 a[112:115], v2, s[52:55], s72 offen offset:0 sc1
    s_sleep 2
    s_add_u32 s72, s77, 61440
    buffer_load_dwordx4 a[116:119], v2, s[52:55], s72 offen offset:1024 sc1
    s_sleep 2
    s_add_u32 s72, s77, 61440
    buffer_load_dwordx4 a[120:123], v2, s[52:55], s72 offen offset:2048 sc1
    s_sleep 2
    s_add_u32 s72, s77, 61440
    buffer_load_dwordx4 a[124:127], v2, s[52:55], s72 offen offset:3072 sc1
    s_sleep 2
    s_add_u32 s72, s77, 0
    buffer_load_dwordx4 v[80:83], v2, s[52:55], s72 offen offset:0 sc1
    s_sleep 2
    s_add_u32 s72, s77, 0
    buffer_load_dwordx4 v[84:87], v2, s[52:55], s72 offen offset:1024 sc1
    s_sleep 2
    s_add_u32 s72, s77, 0
    buffer_load_dwordx4 v[88:91], v2, s[52:55], s72 offen offset:2048 sc1
    s_sleep 2
    s_setprio 3
    s_lshl_b32 s74, s61, 13
    v_add_u32 v12, s74, v2
    v_and_b32 v6, 7, v1
    v_lshlrev_b32 v6, 3, v6
    v_lshrrev_b32 v7, 3, v1
    v_lshl_add_u32 v6, v7, 14, v6
    s_lshl_b32 s73, s11, 8
    s_lshl_b32 s74, s61, 6
    s_add_u32 s73, s73, s74
    s_add_u32 s73, s73, 16384
    s_lshl_b32 s76, s11, 15
    s_lshl_b32 s74, s61, 13
    s_add_u32 s76, s76, s74
    s_add_u32 s76, s76, 8388608
    s_add_u32 s74, s76, 4096
    s_mov_b32 s7, 0
    s_mov_b32 exec_lo, 0xffff
    s_mov_b32 exec_hi, 0x0
L_poll_47:
    buffer_load_dwordx2 v[8:9], v6, s[52:55], s73 offen sc1
    s_waitcnt vmcnt(0)
    v_cmp_ne_u64 vcc, s[56:57], v[8:9]
    s_add_u32 s7, s7, 1
    s_cmp_eq_u64 vcc, 0
    s_cbranch_scc1 L_polled_48
    s_sleep 2
    s_cmp_lt_u32 s7, 65536
    s_cbranch_scc1 L_poll_47
L_polled_48:
    s_mov_b64 exec, -1
    buffer_load_dwordx4 v[32:35], v2, s[52:55], s76 offen offset:0 sc1
    buffer_load_dwordx4 v[36:39], v2, s[52:55], s76 offen offset:1024 sc1
    buffer_load_dwordx4 v[40:43], v2, s[52:55], s76 offen offset:2048 sc1
    buffer_load_dwordx4 v[44:47], v2, s[52:55], s76 offen offset:3072 sc1
    buffer_load_dwordx4 v[64:67], v2, s[52:55], s74 offen offset:0 sc1
    buffer_load_dwordx4 v[68:71], v2, s[52:55], s74 offen offset:1024 sc1
    buffer_load_dwordx4 v[72:75], v2, s[52:55], s74 offen offset:2048 sc1
    buffer_load_dwordx4 v[76:79], v2, s[52:55], s74 offen offset:3072 sc1
    s_setprio 0
    s_add_u32 s72, s77, 0
    buffer_load_dwordx4 v[92:95], v2, s[52:55], s72 offen offset:3072 sc1
    s_sleep 2
    s_add_u32 s72, s77, 4096
    buffer_load_dwordx4 v[96:99], v2, s[52:55], s72 offen offset:0 sc1
    s_sleep 2
    s_add_u32 s72, s77, 4096
    buffer_load_dwordx4 v[100:103], v2, s[52:55], s72 offen offset:1024 sc1
    s_sleep 2
    s_add_u32 s72, s77, 4096
    buffer_load_dwordx4 v[104:107], v2, s[52:55], s72 offen offset:2048 sc1
    s_sleep 2
    s_add_u32 s72, s77, 4096
    buffer_load_dwordx4 v[108:111], v2, s[52:55], s72 offen offset:3072 sc1
    s_sleep 2
    s_add_u32 s72, s77, 8192
    buffer_load_dwordx4 v[112:115], v2, s[52:55], s72 offen offset:0 sc1
    s_sleep 2
    s_add_u32 s72, s77, 8192
    buffer_load_dwordx4 v[116:119], v2, s[52:55], s72 offen offset:1024 sc1
    s_sleep 2
    s_add_u32 s72, s77, 8192
    buffer_load_dwordx4 v[120:123], v2, s[52:55], s72 offen offset:2048 sc1
    s_sleep 2
    s_add_u32 s72, s77, 8192
    buffer_load_dwordx4 v[124:127], v2, s[52:55], s72 offen offset:3072 sc1
    s_sleep 2
    s_add_u32 m0, s5, 0
    s_add_u32 s72, s77, 12288
    buffer_load_dwordx4 v2, s[52:55], s72 offen sc1 lds
    s_sleep 2
    s_add_u32 m0, s5, 1024
    s_add_u32 s72, s77, 13312
    buffer_load_dwordx4 v2, s[52:55], s72 offen sc1 lds
    s_sleep 2
    s_add_u32 m0, s5, 2048
    s_add_u32 s72, s77, 14336
    buffer_load_dwordx4 v2, s[52:55], s72 offen sc1 lds
    s_sleep 2
    s_add_u32 m0, s5, 3072
    s_add_u32 s72, s77, 15360
    buffer_load_dwordx4 v2, s[52:55], s72 offen sc1 lds
    s_sleep 2
    s_add_u32 m0, s5, 4096
    s_add_u32 s72, s77, 16384
    buffer_load_dwordx4 v2, s[52:55], s72 offen sc1 lds
    s_sleep 2
    s_setprio 3
    s_waitcnt vmcnt(21)
    ds_write_b128 v12, v[32:35] offset:0
    s_waitcnt vmcnt(20)
    ds_write_b128 v12, v[36:39] offset:1024
    s_waitcnt vmcnt(19)
    ds_write_b128 v12, v[40:43] offset:2048
    s_waitcnt vmcnt(18)
    ds_write_b128 v12, v[44:47] offset:3072
    s_waitcnt vmcnt(17)
    ds_write_b128 v12, v[64:67] offset:4096
    s_waitcnt vmcnt(16)
    ds_write_b128 v12, v[68:71] offset:5120
    s_waitcnt vmcnt(15)
    ds_write_b128 v12, v[72:75] offset:6144
    s_waitcnt vmcnt(14)
    ds_write_b128 v12, v[76:79] offset:7168
    s_add_u32 s76, s76, 4292870144
    s_add_u32 s74, s76, 4096
    v_and_b32 v5, 31, v1
    v_lshlrev_b32 v7, 2, v5
    v_add_u32 v7, 161856, v7
    ds_read_b32 v10, v7
    v_lshlrev_b32 v5, 10, v5
    v_lshrrev_b32 v7, 5, v1
    v_lshl_add_u32 v13, v7, 4, v5
    s_lshl_b32 s75, s11, 15
    s_add_u32 s75, s75, s12
    v_add_u32 v9, s5, v2
    s_waitcnt lgkmcnt(0)
    v_sub_f32 v11, 1.0, v10
    v_cvt_pk_bf16_f32 v11, v11, v11
    v_and_b32 v11, 0xffff0000, v11
    s_mov_b32 s7, 0
    s_lshl_b32 s14, s58, 1
    s_lshl_b32 s15, s61, 3
    s_sub_u32 s14, s14, s15
    s_lshl_b32 s15, 3, s14
    s_cmp_lt_u32 s14, 8
    s_cselect_b32 s15, s15, 0
    s_andn2_b32 s79, 0xff, s15
    s_waitcnt vmcnt(0)
    s_mov_b32 s13, s79
    s_barrier
    s_barrier
    ds_read_b128 v[48:51], v2 offset:17408
    ds_read_b128 v[52:55], v2 offset:18432
    ds_read_b128 v[56:59], v2 offset:19456
    ds_read_b128 v[60:63], v2 offset:20480
    ds_read_b128 v[64:67], v2 offset:21504
    ds_read_b128 v[68:71], v2 offset:22528
    ds_read_b128 v[72:75], v2 offset:23552
    ds_read_b128 v[76:79], v2 offset:24576
    s_waitcnt lgkmcnt(7)
    v_mfma_f32_32x32x16_bf16 v[16:31], a[68:71], v[48:51], 0
    s_add_u32 s72, s77, 16384
    buffer_load_dwordx4 a[68:71], v2, s[52:55], s72 offen offset:1024 sc1
    ds_read_b128 v[48:51], v2 offset:25600
    s_waitcnt lgkmcnt(7)
    v_mfma_f32_32x32x16_bf16 v[16:31], a[72:75], v[52:55], v[16:31]
    s_add_u32 s72, s77, 16384
    buffer_load_dwordx4 a[72:75], v2, s[52:55], s72 offen offset:2048 sc1
    ds_read_b128 v[52:55], v2 offset:26624
    s_waitcnt lgkmcnt(7)
    v_mfma_f32_32x32x16_bf16 v[16:31], a[76:79], v[56:59], v[16:31]
    s_add_u32 s72, s77, 16384
    buffer_load_dwordx4 a[76:79], v2, s[52:55], s72 offen offset:3072 sc1
    ds_read_b128 v[56:59], v2 offset:27648
    s_waitcnt lgkmcnt(7)
    v_mfma_f32_32x32x16_bf16 v[16:31], a[80:83], v[60:63], v[16:31]
    s_add_u32 s72, s77, 20480
    buffer_load_dwordx4 a[80:83], v2, s[52:55], s72 offen offset:0 sc1
    ds_read_b128 v[60:63], v2 offset:28672
    s_waitcnt lgkmcnt(7)
    v_mfma_f32_32x32x16_bf16 v[16:31], a[84:87], v[64:67], v[16:31]
    s_add_u32 s72, s77, 20480
    buffer_load_dwordx4 a[84:87], v2, s[52:55], s72 offen offset:1024 sc1
    ds_read_b128 v[64:67], v2 offset:29696
    s_waitcnt lgkmcnt(7)
    v_mfma_f32_32x32x16_bf16 v[16:31], a[88:91], v[68:71], v[16:31]
    s_add_u32 s72, s77, 20480
    buffer_load_dwordx4 a[88:91], v2, s[52:55], s72 offen offset:2048 sc1
    ds_read_b128 v[68:71], v2 offset:30720
    s_waitcnt lgkmcnt(7)
    v_mfma_f32_32x32x16_bf16 v[16:31], a[92:95], v[72:75], v[16:31]
    s_add_u32 s72, s77, 20480
    buffer_load_dwordx4 a[92:95], v2, s[52:55], s72 offen offset:3072 sc1
    ds_read_b128 v[72:75], v2 offset:31744
    s_waitcnt lgkmcnt(7)
    v_mfma_f32_32x32x16_bf16 v[16:31], a[96:99], v[76:79], v[16:31]
    s_add_u32 s72, s77, 24576
    buffer_load_dwordx4 a[96:99], v2, s[52:55], s72 offen offset:0 sc1
    ds_read_b128 v[76:79], v2 offset:12288
    s_waitcnt lgkmcnt(7)
    v_mfma_f32_32x32x16_bf16 v[16:31], a[100:103], v[48:51], v[16:31]
    s_add_u32 s72, s77, 24576
    buffer_load_dwordx4 a[100:103], v2, s[52:55], s72 offen offset:1024 sc1
    ds_read_b128 v[48:51], v2 offset:13312
    s_waitcnt lgkmcnt(7)
    v_mfma_f32_32x32x16_bf16 v[16:31], a[104:107], v[52:55], v[16:31]
    s_add_u32 s72, s77, 24576
    buffer_load_dwordx4 a[104:107], v2, s[52:55], s72 offen offset:2048 sc1
    ds_read_b128 v[52:55], v2 offset:14336
    s_waitcnt lgkmcnt(7)
    v_mfma_f32_32x32x16_bf16 v[16:31], a[108:111], v[56:59], v[16:31]
    s_add_u32 s72, s77, 24576
    buffer_load_dwordx4 a[108:111], v2, s[52:55], s72 offen offset:3072 sc1
    ds_read_b128 v[56:59], v2 offset:15360
    s_waitcnt lgkmcnt(7)
    v_mfma_f32_32x32x16_bf16 v[16:31], a[112:115], v[60:63], v[16:31]
    s_add_u32 s72, s77, 28672
    buffer_load_dwordx4 a[112:115], v2, s[52:55], s72 offen offset:0 sc1
    ds_read_b128 v[60:63], v2 offset:16384
    s_waitcnt lgkmcnt(7)
    v_mfma_f32_32x32x16_bf16 v[16:31], a[116:119], v[64:67], v[16:31]
    s_add_u32 s72, s77, 28672
    buffer_load_dwordx4 a[116:119], v2, s[52:55], s72 offen offset:1024 sc1
    ds_read_b128 v[64:67], v2 offset:0
    s_waitcnt lgkmcnt(7)
    v_mfma_f32_32x32x16_bf16 v[16:31], a[120:123], v[68:71], v[16:31]
    s_add_u32 s72, s77, 28672
    buffer_load_dwordx4 a[120:123], v2, s[52:55], s72 offen offset:2048 sc1
    ds_read_b128 v[68:71], v2 offset:1024
    s_waitcnt lgkmcnt(7)
    v_mfma_f32_32x32x16_bf16 v[16:31], a[124:127], v[72:75], v[16:31]
    s_add_u32 s72, s77, 28672
    buffer_load_dwordx4 a[124:127], v2, s[52:55], s72 offen offset:3072 sc1
    ds_read_b128 v[72:75], v2 offset:2048
    s_waitcnt lgkmcnt(7)
    v_mfma_f32_32x32x16_bf16 v[16:31], a[48:51], v[76:79], v[16:31]
    ds_read_b128 a[48:51], v9 offset:0
    ds_read_b128 v[76:79], v2 offset:3072
    s_waitcnt lgkmcnt(8)
    v_mfma_f32_32x32x16_bf16 v[16:31], a[52:55], v[48:51], v[16:31]
    ds_read_b128 a[52:55], v9 offset:1024
    ds_read_b128 v[48:51], v2 offset:4096
    s_waitcnt lgkmcnt(9)
    v_mfma_f32_32x32x16_bf16 v[16:31], a[56:59], v[52:55], v[16:31]
    ds_read_b128 a[56:59], v9 offset:2048
    ds_read_b128 v[52:55], v2 offset:5120
    s_waitcnt lgkmcnt(10)
    v_mfma_f32_32x32x16_bf16 v[16:31], a[60:63], v[56:59], v[16:31]
    ds_read_b128 a[60:63], v9 offset:3072
    ds_read_b128 v[56:59], v2 offset:6144
    s_waitcnt lgkmcnt(11)
    v_mfma_f32_32x32x16_bf16 v[16:31], a[64:67], v[60:63], v[16:31]
    ds_read_b128 a[64:67], v9 offset:4096
    ds_read_b128 v[60:63], v2 offset:7168
    s_waitcnt lgkmcnt(12)
    v_mfma_f32_32x32x16_bf16 v[16:31], a[0:3], v[64:67], v[16:31]
    ds_read_b128 v[64:67], v2 offset:8192
    s_waitcnt lgkmcnt(12)
    v_mfma_f32_32x32x16_bf16 v[16:31], a[4:7], v[68:71], v[16:31]
    ds_read_b128 v[68:71], v2 offset:9216
    s_waitcnt lgkmcnt(12)
    v_mfma_f32_32x32x16_bf16 v[16:31], a[8:11], v[72:75], v[16:31]
    ds_read_b128 v[72:75], v2 offset:10240
    s_waitcnt lgkmcnt(11)
    v_mfma_f32_32x32x16_bf16 v[16:31], a[12:15], v[76:79], v[16:31]
    ds_read_b128 v[76:79], v2 offset:11264
    s_waitcnt lgkmcnt(10)
    v_mfma_f32_32x32x16_bf16 v[16:31], a[16:19], v[48:51], v[16:31]
    s_waitcnt lgkmcnt(8)
    v_mfma_f32_32x32x16_bf16 v[16:31], a[20:23], v[52:55], v[16:31]
    s_waitcnt lgkmcnt(6)
    v_mfma_f32_32x32x16_bf16 v[16:31], a[24:27], v[56:59], v[16:31]
    s_waitcnt lgkmcnt(4)
    v_mfma_f32_32x32x16_bf16 v[16:31], a[28:31], v[60:63], v[16:31]
    s_waitcnt lgkmcnt(3)
    v_mfma_f32_32x32x16_bf16 v[16:31], a[32:35], v[64:67], v[16:31]
    s_waitcnt lgkmcnt(2)
    v_mfma_f32_32x32x16_bf16 v[16:31], a[36:39], v[68:71], v[16:31]
    s_waitcnt lgkmcnt(1)
    v_mfma_f32_32x32x16_bf16 v[16:31], a[40:43], v[72:75], v[16:31]
    s_waitcnt lgkmcnt(0)
    v_mfma_f32_32x32x16_bf16 v[16:31], a[44:47], v[76:79], v[16:31]
    s_bitcmp1_b32 s79, 0
    s_cselect_b64 exec, -1, 0
    buffer_load_dwordx4 v[32:35], v2, s[52:55], s76 offen offset:0 sc1
    s_bitcmp1_b32 s79, 1
    s_cselect_b64 exec, -1, 0
    buffer_load_dwordx4 v[36:39], v2, s[52:55], s76 offen offset:1024 sc1
    s_bitcmp1_b32 s79, 2
    s_cselect_b64 exec, -1, 0
    buffer_load_dwordx4 v[40:43], v2, s[52:55], s76 offen offset:2048 sc1
    s_bitcmp1_b32 s79, 3
    s_cselect_b64 exec, -1, 0
    buffer_load_dwordx4 v[44:47], v2, s[52:55], s76 offen offset:3072 sc1
    s_bitcmp1_b32 s79, 4
    s_cselect_b64 exec, -1, 0
    buffer_load_dwordx4 v[64:67], v2, s[52:55], s74 offen offset:0 sc1
    s_bitcmp1_b32 s79, 5
    s_cselect_b64 exec, -1, 0
    buffer_load_dwordx4 v[68:71], v2, s[52:55], s74 offen offset:1024 sc1
    s_bitcmp1_b32 s79, 6
    s_cselect_b64 exec, -1, 0
    buffer_load_dwordx4 v[72:75], v2, s[52:55], s74 offen offset:2048 sc1
    s_bitcmp1_b32 s79, 7
    s_cselect_b64 exec, -1, 0
    buffer_load_dwordx4 v[76:79], v2, s[52:55], s74 offen offset:3072 sc1
    s_mov_b64 exec, -1
    v_mul_f32 v16, v11, v16
    v_mul_f32 v17, v11, v17
    v_mul_f32 v18, v11, v18
    v_mul_f32 v19, v11, v19
    v_mul_f32 v20, v11, v20
    v_mul_f32 v21, v11, v21
    v_mul_f32 v22, v11, v22
    v_mul_f32 v23, v11, v23
    v_mul_f32 v24, v11, v24
    v_mul_f32 v25, v11, v25
    v_mul_f32 v26, v11, v26
    v_mul_f32 v27, v11, v27
    v_mul_f32 v28, v11, v28
    v_mul_f32 v29, v11, v29
    v_mul_f32 v30, v11, v30
    v_mul_f32 v31, v11, v31
L_try_49:
    s_add_u32 s7, s7, 1
    s_mov_b32 s14, 0
    s_waitcnt vmcnt(0)
    s_bitcmp1_b32 s79, 7
    s_cselect_b64 exec, -1, 0
    ds_write_b128 v12, v[76:79] offset:39936
    v_max3_u32 v8, v76, v77, v78
    v_max_u32 v8, v8, v79
    v_cmp_eq_u32 vcc, -1, v8
    s_cmp_eq_u64 vcc, 0
    s_addc_u32 s14, s14, s14
    s_bitcmp1_b32 s79, 6
    s_cselect_b64 exec, -1, 0
    ds_write_b128 v12, v[72:75] offset:38912
    v_max3_u32 v8, v72, v73, v74
    v_max_u32 v8, v8, v75
    v_cmp_eq_u32 vcc, -1, v8
    s_cmp_eq_u64 vcc, 0
    s_addc_u32 s14, s14, s14
    s_bitcmp1_b32 s79, 5
    s_cselect_b64 exec, -1, 0
    ds_write_b128 v12, v[68:71] offset:37888
    v_max3_u32 v8, v68, v69, v70
    v_max_u32 v8, v8, v71
    v_cmp_eq_u32 vcc, -1, v8
    s_cmp_eq_u64 vcc, 0
    s_addc_u32 s14, s14, s14
    s_bitcmp1_b32 s79, 4
    s_cselect_b64 exec, -1, 0
    ds_write_b128 v12, v[64:67] offset:36864
    v_max3_u32 v8, v64, v65, v66
    v_max_u32 v8, v8, v67
    v_cmp_eq_u32 vcc, -1, v8
    s_cmp_eq_u64 vcc, 0
    s_addc_u32 s14, s14, s14
    s_bitcmp1_b32 s79, 3
    s_cselect_b64 exec, -1, 0
    ds_write_b128 v12, v[44:47] offset:35840
    v_max3_u32 v8, v44, v45, v46
    v_max_u32 v8, v8, v47
    v_cmp_eq_u32 vcc, -1, v8
    s_cmp_eq_u64 vcc, 0
    s_addc_u32 s14, s14, s14
    s_bitcmp1_b32 s79, 2
    s_cselect_b64 exec, -1, 0
    ds_write_b128 v12, v[40:43] offset:34816
    v_max3_u32 v8, v40, v41, v42
    v_max_u32 v8, v8, v43
    v_cmp_eq_u32 vcc, -1, v8
    s_cmp_eq_u64 vcc, 0
    s_addc_u32 s14, s14, s14
    s_bitcmp1_b32 s79, 1
    s_cselect_b64 exec, -1, 0
    ds_write_b128 v12, v[36:39] offset:33792
    v_max3_u32 v8, v36, v37, v38
    v_max_u32 v8, v8, v39
    v_cmp_eq_u32 vcc, -1, v8
    s_cmp_eq_u64 vcc, 0
    s_addc_u32 s14, s14, s14
    s_bitcmp1_b32 s79, 0
    s_cselect_b64 exec, -1, 0
    ds_write_b128 v12, v[32:35] offset:32768
    v_max3_u32 v8, v32, v33, v34
    v_max_u32 v8, v8, v35
    v_cmp_eq_u32 vcc, -1, v8
    s_cmp_eq_u64 vcc, 0
    s_addc_u32 s14, s14, s14
    s_mov_b64 exec, -1
    s_andn2_b32 s79, s79, s14
    s_cbranch_scc0 L_got_50
    s_sleep 4
    s_bitcmp1_b32 s79, 0
    s_cselect_b64 exec, -1, 0
    buffer_load_dwordx4 v[32:35], v2, s[52:55], s76 offen offset:0 sc1
    s_bitcmp1_b32 s79, 1
    s_cselect_b64 exec, -1, 0
    buffer_load_dwordx4 v[36:39], v2, s[52:55], s76 offen offset:1024 sc1
    s_bitcmp1_b32 s79, 2
    s_cselect_b64 exec, -1, 0
    buffer_load_dwordx4 v[40:43], v2, s[52:55], s76 offen offset:2048 sc1
    s_bitcmp1_b32 s79, 3
    s_cselect_b64 exec, -1, 0
    buffer_load_dwordx4 v[44:47], v2, s[52:55], s76 offen offset:3072 sc1
    s_bitcmp1_b32 s79, 4
    s_cselect_b64 exec, -1, 0
    buffer_load_dwordx4 v[64:67], v2, s[52:55], s74 offen offset:0 sc1
    s_bitcmp1_b32 s79, 5
    s_cselect_b64 exec, -1, 0
    buffer_load_dwordx4 v[68:71], v2, s[52:55], s74 offen offset:1024 sc1
    s_bitcmp1_b32 s79, 6
    s_cselect_b64 exec, -1, 0
    buffer_load_dwordx4 v[72:75], v2, s[52:55], s74 offen offset:2048 sc1
    s_bitcmp1_b32 s79, 7
    s_cselect_b64 exec, -1, 0
    buffer_load_dwordx4 v[76:79], v2, s[52:55], s74 offen offset:3072 sc1
    s_mov_b64 exec, -1
    s_cmp_lt_u32 s7, 65536
    s_cbranch_scc1 L_try_49
    s_waitcnt vmcnt(0)
L_got_50:
    s_mov_b64 exec, -1
    s_waitcnt lgkmcnt(0)
    s_barrier
    ds_read_b128 v[48:51], v2 offset:32768
    ds_read_b128 v[52:55], v2 offset:33792
    ds_read_b128 v[56:59], v2 offset:34816
    ds_read_b128 v[60:63], v2 offset:35840
    ds_read_b128 v[64:67], v2 offset:36864
    ds_read_b128 v[68:71], v2 offset:37888
    ds_read_b128 v[72:75], v2 offset:38912
    ds_read_b128 v[76:79], v2 offset:39936
    s_waitcnt lgkmcnt(7)
    v_mfma_f32_32x32x16_bf16 v[32:47], v[80:83], v[48:51], 0
    ds_read_b128 v[48:51], v2 offset:40960
    s_waitcnt lgkmcnt(7)
    v_mfma_f32_32x32x16_bf16 v[32:47], v[84:87], v[52:55], v[32:47]
    ds_read_b128 v[52:55], v2 offset:41984
    s_waitcnt lgkmcnt(7)
    v_mfma_f32_32x32x16_bf16 v[32:47], v[88:91], v[56:59], v[32:47]
    ds_read_b128 v[56:59], v2 offset:43008
    s_waitcnt lgkmcnt(7)
    v_mfma_f32_32x32x16_bf16 v[32:47], v[92:95], v[60:63], v[32:47]
    ds_read_b128 v[60:63], v2 offset:44032
    s_waitcnt lgkmcnt(7)
    v_mfma_f32_32x32x16_bf16 v[32:47], v[96:99], v[64:67], v[32:47]
    ds_read_b128 v[64:67], v2 offset:45056
    s_waitcnt lgkmcnt(7)
    v_mfma_f32_32x32x16_bf16 v[32:47], v[100:103], v[68:71], v[32:47]
    ds_read_b128 v[68:71], v2 offset:46080
    s_waitcnt lgkmcnt(7)
    v_mfma_f32_32x32x16_bf16 v[32:47], v[104:107], v[72:75], v[32:47]
    ds_read_b128 v[72:75], v2 offset:47104
    s_waitcnt lgkmcnt(7)
    v_mfma_f32_32x32x16_bf16 v[32:47], v[108:111], v[76:79], v[32:47]
    ds_read_b128 v[76:79], v2 offset:48128
    s_waitcnt lgkmcnt(7)
    v_mfma_f32_32x32x16_bf16 v[32:47], v[112:115], v[48:51], v[32:47]
    ds_read_b128 v[48:51], v2 offset:49152
    s_waitcnt lgkmcnt(7)
    v_mfma_f32_32x32x16_bf16 v[32:47], v[116:119], v[52:55], v[32:47]
    ds_read_b128 v[52:55], v2 offset:50176
    s_waitcnt lgkmcnt(7)
    v_mfma_f32_32x32x16_bf16 v[32:47], v[120:123], v[56:59], v[32:47]
    ds_read_b128 v[56:59], v2 offset:51200
    s_waitcnt lgkmcnt(7)
    v_mfma_f32_32x32x16_bf16 v[32:47], v[124:127], v[60:63], v[32:47]
    ds_read_b128 v[60:63], v2 offset:52224
    s_waitcnt lgkmcnt(7)
    v_mfma_f32_32x32x16_bf16 v[32:47], a[48:51], v[64:67], v[32:47]
    ds_read_b128 v[64:67], v2 offset:53248
    s_waitcnt lgkmcnt(7)
    v_mfma_f32_32x32x16_bf16 v[32:47], a[52:55], v[68:71], v[32:47]
    ds_read_b128 v[68:71], v2 offset:54272
    s_waitcnt lgkmcnt(7)
    v_mfma_f32_32x32x16_bf16 v[32:47], a[56:59], v[72:75], v[32:47]
    ds_read_b128 v[72:75], v2 offset:55296
    s_waitcnt lgkmcnt(7)
    v_mfma_f32_32x32x16_bf16 v[32:47], a[60:63], v[76:79], v[32:47]
    ds_read_b128 v[76:79], v2 offset:56320
    s_waitcnt lgkmcnt(7)
    v_mfma_f32_32x32x16_bf16 v[32:47], a[64:67], v[48:51], v[32:47]
    ds_read_b128 v[48:51], v2 offset:57344
    s_waitcnt lgkmcnt(7)
    v_mfma_f32_32x32x16_bf16 v[32:47], a[68:71], v[52:55], v[32:47]
    ds_read_b128 v[52:55], v2 offset:58368
    s_waitcnt lgkmcnt(7)
    v_mfma_f32_32x32x16_bf16 v[32:47], a[72:75], v[56:59], v[32:47]
    ds_read_b128 v[56:59], v2 offset:59392
    s_waitcnt lgkmcnt(7)
    v_mfma_f32_32x32x16_bf16 v[32:47], a[76:79], v[60:63], v[32:47]
    ds_read_b128 v[60:63], v2 offset:60416
    s_waitcnt lgkmcnt(7)
    v_mfma_f32_32x32x16_bf16 v[32:47], a[80:83], v[64:67], v[32:47]
    ds_read_b128 v[64:67], v2 offset:61440
    s_waitcnt lgkmcnt(7)
    v_mfma_f32_32x32x16_bf16 v[32:47], a[84:87], v[68:71], v[32:47]
    ds_read_b128 v[68:71], v2 offset:62464
    s_waitcnt lgkmcnt(7)
    v_mfma_f32_32x32x16_bf16 v[32:47], a[88:91], v[72:75], v[32:47]
    ds_read_b128 v[72:75], v2 offset:63488
    s_waitcnt lgkmcnt(7)
    v_mfma_f32_32x32x16_bf16 v[32:47], a[92:95], v[76:79], v[32:47]
    ds_read_b128 v[76:79], v2 offset:64512
    s_waitcnt lgkmcnt(7)
    v_mfma_f32_32x32x16_bf16 v[32:47], a[96:99], v[48:51], v[32:47]
    s_waitcnt lgkmcnt(6)
    v_mfma_f32_32x32x16_bf16 v[32:47], a[100:103], v[52:55], v[32:47]
    s_waitcnt lgkmcnt(5)
    v_mfma_f32_32x32x16_bf16 v[32:47], a[104:107], v[56:59], v[32:47]
    s_waitcnt lgkmcnt(4)
    v_mfma_f32_32x32x16_bf16 v[32:47], a[108:111], v[60:63], v[32:47]
    s_waitcnt lgkmcnt(3)
    v_mfma_f32_32x32x16_bf16 v[32:47], a[112:115], v[64:67], v[32:47]
    s_waitcnt lgkmcnt(2)
    v_mfma_f32_32x32x16_bf16 v[32:47], a[116:119], v[68:71], v[32:47]
    s_waitcnt lgkmcnt(1)
    v_mfma_f32_32x32x16_bf16 v[32:47], a[120:123], v[72:75], v[32:47]
    s_waitcnt lgkmcnt(0)
    v_mfma_f32_32x32x16_bf16 v[32:47], a[124:127], v[76:79], v[32:47]
    s_or_b32 s72, s2, s61
    s_cmp_lg_u32 s72, 0
    s_cbranch_scc1 L_noepoch_51
    v_mov_b32 v5, 0
    s_mov_b32 s72, 0
    v_mov_b32 v8, s56
    v_mov_b32 v9, s57
    s_mov_b64 exec, 0x1
    buffer_store_dwordx2 v[8:9], v5, s[52:55], s72 offen sc1
    s_mov_b64 exec, -1
L_noepoch_51:
    s_nop 8
    v_fma_f32 v32, v10, v32, v16
    v_fma_f32 v33, v10, v33, v17
    v_fma_f32 v34, v10, v34, v18
    v_fma_f32 v35, v10, v35, v19
    v_fma_f32 v36, v10, v36, v20
    v_fma_f32 v37, v10, v37, v21
    v_fma_f32 v38, v10, v38, v22
    v_fma_f32 v39, v10, v39, v23
    v_fma_f32 v40, v10, v40, v24
    v_fma_f32 v41, v10, v41, v25
    v_fma_f32 v42, v10, v42, v26
    v_fma_f32 v43, v10, v43, v27
    v_fma_f32 v44, v10, v44, v28
    v_fma_f32 v45, v10, v45, v29
    v_fma_f32 v46, v10, v46, v30
    v_fma_f32 v47, v10, v47, v31
    v_cvt_pk_bf16_f32 v48, v32, v33
    v_cvt_pk_bf16_f32 v49, v34, v35
    v_cvt_pk_bf16_f32 v50, v36, v37
    v_cvt_pk_bf16_f32 v51, v38, v39
    v_cvt_pk_bf16_f32 v52, v40, v41
    v_cvt_pk_bf16_f32 v53, v42, v43
    v_cvt_pk_bf16_f32 v54, v44, v45
    v_cvt_pk_bf16_f32 v55, v46, v47
    s_nop 1
    v_permlane32_swap_b32 v48, v50
    v_permlane32_swap_b32 v49, v51
    v_permlane32_swap_b32 v52, v54
    v_permlane32_swap_b32 v53, v55
    buffer_store_dwordx4 v[48:51], v13, s[48:51], s75 offen nt
    buffer_store_dwordx4 v[52:55], v13, s[48:51], s75 offen offset:32 nt
    s_endpgm
L_bfinal:
    ds_write_b128 v4, a[32:35] offset:0
    ds_write_b128 v4, a[36:39] offset:1024
    ds_write_b32 v5, a40 offset:2048
    v_accvgpr_read_b32 v104, a0
    v_accvgpr_read_b32 v105, a1
    v_accvgpr_read_b32 v106, a2
    v_accvgpr_read_b32 v107, a3
    v_accvgpr_read_b32 v108, a4
    v_accvgpr_read_b32 v109, a5
    v_accvgpr_read_b32 v110, a6
    v_accvgpr_read_b32 v111, a7
    v_accvgpr_read_b32 v112, a8
    ds_write_b128 v4, a[48:51] offset:2304
    ds_write_b128 v4, a[52:55] offset:3328
    ds_write_b32 v5, a56 offset:4352
    v_accvgpr_read_b32 v114, a16
    v_accvgpr_read_b32 v115, a17
    v_accvgpr_read_b32 v116, a18
    v_accvgpr_read_b32 v117, a19
    v_accvgpr_read_b32 v118, a20
    v_accvgpr_read_b32 v119, a21
    v_accvgpr_read_b32 v120, a22
    v_accvgpr_read_b32 v121, a23
    v_accvgpr_read_b32 v122, a24
    s_waitcnt lgkmcnt(0)
    s_barrier
    ds_read_b128 v[32:35], v6 offset:0
    ds_read_b128 v[36:39], v6 offset:1024
    ds_read_b32 v40, v7 offset:2048
    ds_read_b128 v[44:47], v6 offset:2304
    ds_read_b128 v[48:51], v6 offset:3328
    ds_read_b32 v52, v7 offset:4352
    ds_read_b128 v[56:59], v8 offset:0
    ds_read_b128 v[60:63], v8 offset:1024
    ds_read_b32 v64, v9 offset:2048
    ds_read_b128 v[68:71], v8 offset:2304
    ds_read_b128 v[72:75], v8 offset:3328
    ds_read_b32 v76, v9 offset:4352
    s_waitcnt lgkmcnt(6)
    v_pk_add_f32 v[104:105], v[104:105], v[32:33]
    v_pk_add_f32 v[106:107], v[106:107], v[34:35]
    v_pk_add_f32 v[108:109], v[108:109], v[36:37]
    v_pk_add_f32 v[110:111], v[110:111], v[38:39]
    v_add_f32 v112, v112, v40
    v_pk_add_f32 v[114:115], v[114:115], v[44:45]
    v_pk_add_f32 v[116:117], v[116:117], v[46:47]
    v_pk_add_f32 v[118:119], v[118:119], v[48:49]
    v_pk_add_f32 v[120:121], v[120:121], v[50:51]
    v_add_f32 v122, v122, v52
    ds_read_b128 v[80:83], v8 offset:18432
    ds_read_b128 v[84:87], v8 offset:19456
    ds_read_b32 v88, v9 offset:20480
    ds_read_b128 v[92:95], v8 offset:20736
    ds_read_b128 v[96:99], v8 offset:21760
    ds_read_b32 v100, v9 offset:22784
    s_waitcnt lgkmcnt(6)
    v_pk_add_f32 v[104:105], v[104:105], v[56:57]
    v_pk_add_f32 v[106:107], v[106:107], v[58:59]
    v_pk_add_f32 v[108:109], v[108:109], v[60:61]
    v_pk_add_f32 v[110:111], v[110:111], v[62:63]
    v_add_f32 v112, v112, v64
    v_pk_add_f32 v[114:115], v[114:115], v[68:69]
    v_pk_add_f32 v[116:117], v[116:117], v[70:71]
    v_pk_add_f32 v[118:119], v[118:119], v[72:73]
    v_pk_add_f32 v[120:121], v[120:121], v[74:75]
    v_add_f32 v122, v122, v76
    s_waitcnt lgkmcnt(0)
    v_pk_add_f32 v[104:105], v[104:105], v[80:81]
    v_pk_add_f32 v[106:107], v[106:107], v[82:83]
    v_pk_add_f32 v[108:109], v[108:109], v[84:85]
    v_pk_add_f32 v[110:111], v[110:111], v[86:87]
    v_add_f32 v112, v112, v88
    v_pk_add_f32 v[114:115], v[114:115], v[92:93]
    v_pk_add_f32 v[116:117], v[116:117], v[94:95]
    v_pk_add_f32 v[118:119], v[118:119], v[96:97]
    v_pk_add_f32 v[120:121], v[120:121], v[98:99]
    v_add_f32 v122, v122, v100
    s_mov_b32 s73, 0x2f800000
    s_mov_b32 s74, 0x5f800000
    v_pk_add_f32 v[36:37], v[104:105], v[106:107]
    v_pk_add_f32 v[38:39], v[108:109], v[110:111]
    v_pk_add_f32 v[36:37], v[36:37], v[38:39]
    v_add_f32 v36, v36, v37
    v_fma_f32 v32, 0, v36, v112
    v_pk_add_f32 v[40:41], v[114:115], v[116:117]
    v_pk_add_f32 v[42:43], v[118:119], v[120:121]
    v_pk_add_f32 v[40:41], v[40:41], v[42:43]
    v_add_f32 v40, v40, v41
    v_fma_f32 v33, 0, v40, v122
    s_mov_b64 s[8:9], 0
    v_cmp_nle_f32 vcc, s73, v32
    s_or_b64 s[8:9], s[8:9], vcc
    v_cmp_nge_f32 vcc, s74, v32
    s_or_b64 s[8:9], s[8:9], vcc
    v_cmp_nle_f32 vcc, s73, v33
    s_or_b64 s[8:9], s[8:9], vcc
    v_cmp_nge_f32 vcc, s74, v33
    s_or_b64 s[8:9], s[8:9], vcc
    s_cmp_lg_u64 s[8:9], 0
    s_cbranch_scc1 L_slow
L_norm:
    v_rcp_f32 v32, v112
    v_rcp_f32 v33, v122
    s_nop 0
    v_mul_f32 v104, v32, v104
    v_mul_f32 v105, v32, v105
    v_mul_f32 v106, v32, v106
    v_mul_f32 v107, v32, v107
    v_mul_f32 v108, v32, v108
    v_mul_f32 v109, v32, v109
    v_mul_f32 v110, v32, v110
    v_mul_f32 v111, v32, v111
    v_cvt_pk_bf16_f32 v36, v104, v105
    v_cvt_pk_bf16_f32 v37, v106, v107
    v_cvt_pk_bf16_f32 v38, v108, v109
    v_cvt_pk_bf16_f32 v39, v110, v111
    buffer_store_dwordx4 v[36:39], v2, s[52:55], s76 offen sc1
    v_mul_f32 v114, v33, v114
    v_mul_f32 v115, v33, v115
    v_mul_f32 v116, v33, v116
    v_mul_f32 v117, v33, v117
    v_mul_f32 v118, v33, v118
    v_mul_f32 v119, v33, v119
    v_mul_f32 v120, v33, v120
    v_mul_f32 v121, v33, v121
    v_cvt_pk_bf16_f32 v40, v114, v115
    v_cvt_pk_bf16_f32 v41, v116, v117
    v_cvt_pk_bf16_f32 v42, v118, v119
    v_cvt_pk_bf16_f32 v43, v120, v121
    buffer_store_dwordx4 v[40:43], v2, s[52:55], s12 offen sc1
    s_cmp_gt_u32 s3, 1
    s_cbranch_scc1 L_nown_52
    s_cmp_eq_u32 s3, 0
    s_cselect_b64 vcc, -1, 0
    v_cndmask_b32 v44, v40, v36, vcc
    v_cndmask_b32 v45, v41, v37, vcc
    v_cndmask_b32 v46, v42, v38, vcc
    v_cndmask_b32 v47, v43, v39, vcc
    ds_write_b128 v10, v[44:47] offset:32768
    s_waitcnt lgkmcnt(0)
L_nown_52:
    s_barrier
    s_endpgm
L_slow:
    s_lshl_b32 s73, s58, 18
    s_lshl_b32 s74, s63, 17
    s_add_u32 s73, s73, s74
    s_add_u32 s73, s73, 1048576
    v_add_u32 v126, s73, v2
    v_add_u32 v127, s73, v15
    v_mov_b32 v124, 0xff800000
    s_mov_b32 s78, 0
L_max_53:
    buffer_load_dwordx4 a[64:67], v126, s[52:55], s78 offen sc1
    s_waitcnt vmcnt(0)
    v_mfma_f32_32x32x16_bf16 v[32:47], a[64:67], v[16:19], 0
    s_nop 11
    v_max3_f32 v124, v32, v33, v124
    v_max3_f32 v124, v34, v35, v124
    v_max3_f32 v124, v36, v37, v124
    v_max3_f32 v124, v38, v39, v124
    v_max3_f32 v124, v40, v41, v124
    v_max3_f32 v124, v42, v43, v124
    v_max3_f32 v124, v44, v45, v124
    v_max3_f32 v124, v46, v47, v124
    s_add_u32 s78, s78, 2048
    s_cmp_lt_u32 s78, 131072
    s_cbranch_scc1 L_max_53
    v_mov_b32 v32, v124
    s_nop 1
    v_permlane32_swap_b32 v32, v124
    s_nop 1
    v_max_f32 v124, v32, v124
    v_mov_b32 v48, 0
    v_mov_b32 v49, 0
    v_mov_b32 v50, 0
    v_mov_b32 v51, 0
    v_mov_b32 v52, 0
    v_mov_b32 v53, 0
    v_mov_b32 v54, 0
    v_mov_b32 v55, 0
    v_mov_b32 v56, 0
    v_mov_b32 v57, 0
    v_mov_b32 v58, 0
    v_mov_b32 v59, 0
    v_mov_b32 v60, 0
    v_mov_b32 v61, 0
    v_mov_b32 v62, 0
    v_mov_b32 v63, 0
    s_mov_b32 s78, 0
L_sum_54:
    buffer_load_dwordx4 a[64:67], v126, s[52:55], s78 offen sc1
    s_mov_b64 exec, s[80:81]
    buffer_load_dwordx4 a[84:87], v127, s[52:55], s78 offen sc1
    buffer_load_dwordx4 a[88:91], v127, s[52:55], s78 offen offset:512 sc1
    s_mov_b64 exec, -1
    s_waitcnt vmcnt(0)
    v_mfma_f32_32x32x16_bf16 v[32:47], a[64:67], v[16:19], 0
    s_nop 11
    v_sub_f32 v32, v32, v124
    v_sub_f32 v33, v33, v124
    v_sub_f32 v34, v34, v124
    v_sub_f32 v35, v35, v124
    v_sub_f32 v36, v36, v124
    v_sub_f32 v37, v37, v124
    v_sub_f32 v38, v38, v124
    v_sub_f32 v39, v39, v124
    v_sub_f32 v40, v40, v124
    v_sub_f32 v41, v41, v124
    v_sub_f32 v42, v42, v124
    v_sub_f32 v43, v43, v124
    v_sub_f32 v44, v44, v124
    v_sub_f32 v45, v45, v124
    v_sub_f32 v46, v46, v124
    v_sub_f32 v47, v47, v124
    v_exp_f32 v32, v32
    v_exp_f32 v33, v33
    v_exp_f32 v34, v34
    v_exp_f32 v35, v35
    v_exp_f32 v36, v36
    v_exp_f32 v37, v37
    v_exp_f32 v38, v38
    v_exp_f32 v39, v39
    v_exp_f32 v40, v40
    v_exp_f32 v41, v41
    v_exp_f32 v42, v42
    v_exp_f32 v43, v43
    v_exp_f32 v44, v44
    v_exp_f32 v45, v45
    v_exp_f32 v46, v46
    v_exp_f32 v47, v47
    s_nop 1
    v_smfmac_f32_32x32x32_bf16 v[48:63], a[84:87], v[32:39], v125
    v_smfmac_f32_32x32x32_bf16 v[48:63], a[88:91], v[40:47], v125
    s_add_u32 s78, s78, 2048
    s_cmp_lt_u32 s78, 131072
    s_cbranch_scc1 L_sum_54
    s_nop 11
    v_mov_b32 v104, v48
    v_mov_b32 v105, v49
    v_mov_b32 v106, v50
    v_mov_b32 v107, v51
    v_mov_b32 v108, v52
    v_mov_b32 v109, v53
    v_mov_b32 v110, v54
    v_mov_b32 v111, v55
    v_mov_b32 v112, v56
    v_mov_b32 v124, 0xff800000
    s_mov_b32 s78, 0
L_max_55:
    buffer_load_dwordx4 a[64:67], v126, s[52:55], s78 offen sc1
    s_waitcnt vmcnt(0)
    v_mfma_f32_32x32x16_bf16 v[32:47], a[64:67], v[20:23], 0
    s_nop 11
    v_max3_f32 v124, v32, v33, v124
    v_max3_f32 v124, v34, v35, v124
    v_max3_f32 v124, v36, v37, v124
    v_max3_f32 v124, v38, v39, v124
    v_max3_f32 v124, v40, v41, v124
    v_max3_f32 v124, v42, v43, v124
    v_max3_f32 v124, v44, v45, v124
    v_max3_f32 v124, v46, v47, v124
    s_add_u32 s78, s78, 2048
    s_cmp_lt_u32 s78, 131072
    s_cbranch_scc1 L_max_55
    v_mov_b32 v32, v124
    s_nop 1
    v_permlane32_swap_b32 v32, v124
    s_nop 1
    v_max_f32 v124, v32, v124
    v_mov_b32 v48, 0
    v_mov_b32 v49, 0
    v_mov_b32 v50, 0
    v_mov_b32 v51, 0
    v_mov_b32 v52, 0
    v_mov_b32 v53, 0
    v_mov_b32 v54, 0
    v_mov_b32 v55, 0
    v_mov_b32 v56, 0
    v_mov_b32 v57, 0
    v_mov_b32 v58, 0
    v_mov_b32 v59, 0
    v_mov_b32 v60, 0
    v_mov_b32 v61, 0
    v_mov_b32 v62, 0
    v_mov_b32 v63, 0
    s_mov_b32 s78, 0
L_sum_56:
    buffer_load_dwordx4 a[64:67], v126, s[52:55], s78 offen sc1
    s_mov_b64 exec, s[80:81]
    buffer_load_dwordx4 a[84:87], v127, s[52:55], s78 offen sc1
    buffer_load_dwordx4 a[88:91], v127, s[52:55], s78 offen offset:512 sc1
    s_mov_b64 exec, -1
    s_waitcnt vmcnt(0)
    v_mfma_f32_32x32x16_bf16 v[32:47], a[64:67], v[20:23], 0
    s_nop 11
    v_sub_f32 v32, v32, v124
    v_sub_f32 v33, v33, v124
    v_sub_f32 v34, v34, v124
    v_sub_f32 v35, v35, v124
    v_sub_f32 v36, v36, v124
    v_sub_f32 v37, v37, v124
    v_sub_f32 v38, v38, v124
    v_sub_f32 v39, v39, v124
    v_sub_f32 v40, v40, v124
    v_sub_f32 v41, v41, v124
    v_sub_f32 v42, v42, v124
    v_sub_f32 v43, v43, v124
    v_sub_f32 v44, v44, v124
    v_sub_f32 v45, v45, v124
    v_sub_f32 v46, v46, v124
    v_sub_f32 v47, v47, v124
    v_exp_f32 v32, v32
    v_exp_f32 v33, v33
    v_exp_f32 v34, v34
    v_exp_f32 v35, v35
    v_exp_f32 v36, v36
    v_exp_f32 v37, v37
    v_exp_f32 v38, v38
    v_exp_f32 v39, v39
    v_exp_f32 v40, v40
    v_exp_f32 v41, v41
    v_exp_f32 v42, v42
    v_exp_f32 v43, v43
    v_exp_f32 v44, v44
    v_exp_f32 v45, v45
    v_exp_f32 v46, v46
    v_exp_f32 v47, v47
    s_nop 1
    v_smfmac_f32_32x32x32_bf16 v[48:63], a[84:87], v[32:39], v125
    v_smfmac_f32_32x32x32_bf16 v[48:63], a[88:91], v[40:47], v125
    s_add_u32 s78, s78, 2048
    s_cmp_lt_u32 s78, 131072
    s_cbranch_scc1 L_sum_56
    s_nop 11
    v_mov_b32 v114, v48
    v_mov_b32 v115, v49
    v_mov_b32 v116, v50
    v_mov_b32 v117, v51
    v_mov_b32 v118, v52
    v_mov_b32 v119, v53
    v_mov_b32 v120, v54
    v_mov_b32 v121, v55
    v_mov_b32 v122, v56
    s_branch L_norm
L_end:
    s_endpgm
.section .rodata,"a"
.p2align 6
.amdhsa_kernel gated_mix__softmax_full_mha__linear_attn_block__prompt_kernel
  .amdhsa_next_free_vgpr 256
  .amdhsa_next_free_sgpr 102
  .amdhsa_accum_offset 128
  .amdhsa_group_segment_fixed_size 0
  .amdhsa_kernarg_size 80
  .amdhsa_user_sgpr_count 2
  .amdhsa_user_sgpr_kernarg_segment_ptr 1
  .amdhsa_system_sgpr_workgroup_id_x 1
.end_amdhsa_kernel
```
